```python
import torch

def _softmax(x, axis=-1):
    return torch.softmax(x, dim=axis)
def _gelu(x):
    return torch.nn.functional.gelu(x, approximate="tanh")
def _silu(x):
    return torch.nn.functional.silu(x)
def _sigmoid(x):
    return torch.sigmoid(x)
def _layernorm(x, axis=-1, eps=1e-5):
    m = x.mean(dim=axis, keepdim=True)
    v = x.var(dim=axis, keepdim=True, unbiased=False)
    return (x - m) / torch.sqrt(v + eps)
def _scatter_add(tgt, idx, src, axis=0):
    return tgt.clone().index_add_(axis, idx, src)
def _segment_sum(src, seg, n):
    out = torch.zeros((n,) + src.shape[1:], dtype=src.dtype)
    return out.index_add_(0, seg, src)
def _pad(x, pw):
    flat = tuple(v for pair in reversed(pw) for v in pair)
    return torch.nn.functional.pad(x, flat)

kernel_name = 'recurrent_scan__softmax_full_mha__mixer_channel_mlp__prompt'

def setup_inputs():

    _w = (lambda a: (lambda t: t.to(torch.bfloat16) if t.is_floating_point() else t)(torch.as_tensor(a)))
    def _A_setup():
        B, S, D = 1, 2048, 640
        return {
            "x": _w((lambda *s: torch.randn(*s, dtype=torch.bfloat16) * 0.05)(B, S, D)),
            "wqkv": _w((lambda *s: torch.randn(*s, dtype=torch.bfloat16) * 0.05)(D, 3 * D)),
            "wo": _w((lambda *s: torch.randn(*s, dtype=torch.bfloat16) * 0.05)(D, D)),
        }
    _A_in = _A_setup()

    def _B_setup():
        B, S, D, F = 1, 2048, 640, 1536
        return {
            "x": _w((lambda *s: torch.randn(*s, dtype=torch.bfloat16) * 0.05)(B, S, D)),
            "w1": _w((lambda *s: torch.randn(*s, dtype=torch.bfloat16) * 1.6)(D, F) * (D ** -0.5)),
            "b1": _w((lambda *s: torch.randn(*s, dtype=torch.bfloat16) * 0.8)(F)),
            "w2": _w((lambda *s: torch.randn(*s, dtype=torch.bfloat16) * 0.05)(F, D) * (F ** -0.5)),
            "b2": _w((lambda *s: torch.randn(*s, dtype=torch.bfloat16) * 0.05)(D)),
        }
    _B_in = _B_setup()

    return {
        "A_x": _A_in["x"],
        "A_wqkv": _A_in["wqkv"],
        "A_wo": _A_in["wo"],
        "B_x": _B_in["x"],
        "B_w1": _B_in["w1"],
        "B_b1": _B_in["b1"],
        "B_w2": _B_in["w2"],
        "B_b2": _B_in["b2"],
    }

def reference(A_x, A_wqkv, A_wo, B_x, B_w1, B_b1, B_w2, B_b2):
    def _A_ref(x, wqkv, wo):
        B, S, D = x.shape
        H = 32; Dh = D // H
        qkv = (lambda x, *d: x.permute(*d))((x @ wqkv).reshape(B, S, 3, H, Dh), 2, 0, 3, 1, 4)
        q, k, v = qkv[0], qkv[1], qkv[2]
        scale = Dh ** -0.5
        scores = torch.einsum("bhqd,bhkd->bhqk", q, k) * scale
        p = _softmax(scores, axis=-1)
        o = torch.einsum("bhqk,bhkd->bhqd", p, v)
        return (lambda x, *d: x.permute(*d))(o, 0, 2, 1, 3).reshape(B, S, D) @ wo

    def _B_ref(x, w1, b1, w2, b2):
        y = _layernorm(x, axis=-1)
        h = _gelu(torch.einsum("bsd,df->bsf", y, w1) + b1)
        return torch.einsum("bsf,fd->bsd", h, w2) + b2

    x = A_x
    xn = _layernorm(x, axis=-1)
    s = _A_ref(xn, A_wqkv, A_wo)
    g = _silu(_B_ref(xn, B_w1, B_b1, B_w2, B_b2))
    return x + s * g
```

```asm
; @launch grid=(512,1,1) block=(512,1,1) lds=81920
.amdgcn_target "amdgcn-amd-amdhsa--gfx950"
.text
.p2align 8
.globl recurrent_scan__softmax_full_mha__mixer_channel_mlp__prompt_kernel
.type recurrent_scan__softmax_full_mha__mixer_channel_mlp__prompt_kernel,@function
recurrent_scan__softmax_full_mha__mixer_channel_mlp__prompt_kernel:
    s_load_dwordx2 s[4:5], s[0:1], 80
    s_memrealtime s[82:83]
    s_cmp_ge_u32 s2, 512
    s_cbranch_scc1 L_kf_end
    s_mov_b32 s97, 0
    s_mov_b32 s93, 0
    s_mov_b32 s96, s2
    s_waitcnt lgkmcnt(0)
    s_sub_u32 s90, s82, 200
    s_cmp_ge_u32 s2, 256
    s_cbranch_scc1 L_k2_mlp
    s_and_b32 s37, s2, 7
    s_lshr_b32 s38, s2, 3
    s_and_b32 s20, s37, 1
    s_lshl_b32 s20, s20, 3
    s_and_b32 s39, s38, 7
    s_add_u32 s20, s20, s39
    s_lshr_b32 s21, s37, 1
    s_lshl_b32 s21, s21, 2
    s_lshr_b32 s39, s38, 3
    s_add_u32 s21, s21, s39
    s_cmp_eq_u32 s21, 15
    s_cbranch_scc1 L_k2_att
L_qkv_task:
    s_setprio 2
    s_load_dwordx4 s[56:59], s[0:1], 0
    v_lshrrev_b32 v24, 6, v0
    v_and_b32 v2, 63, v0
    s_nop 0
    v_readfirstlane_b32 s23, v24
    v_and_b32 v3, 31, v2
    v_lshrrev_b32 v1, 5, v2
    s_and_b32 s24, s23, 3
    s_lshr_b32 s25, s23, 2
    s_mul_i32 s22, s21, 52
    s_lshr_b32 s22, s22, 8
    s_mul_i32 s37, s22, 5
    s_sub_u32 s35, s21, s37
    s_lshl_b32 s35, s35, 5
    s_lshl_b32 s27, s21, 7
    s_mov_b32 s26, 3840
    s_min_u32 s37, s23, 7
    s_lshl_b32 s28, s37, 10
    v_lshl_add_u32 v24, v2, 4, s28
    v_lshrrev_b32 v25, 8, v24
    v_bfe_u32 v26, v24, 4, 4
    v_and_b32 v27, 3, v25
    v_lshlrev_b32 v27, 2, v27
    v_xor_b32 v26, v26, v27
    v_lshlrev_b32 v26, 4, v26
    v_mul_lo_u32 v25, v25, s26
    s_lshl_b32 s37, s27, 1
    v_add3_u32 v4, v25, v26, s37
    s_lshl_b32 s49, s23, 10
    s_lshl_b32 s37, s23, 4
    v_lshrrev_b32 v24, 2, v2
    v_add_u32 v24, s37, v24
    v_bfe_u32 v25, v24, 2, 2
    v_and_b32 v26, 3, v2
    v_xor_b32 v25, v25, v26
    s_lshl_b32 s38, s20, 7
    v_add_u32 v24, s38, v24
    v_mul_u32_u24 v24, 1280, v24
    v_lshl_add_u32 v5, v25, 4, v24
    s_lshl_b32 s33, s26, 5
    s_lshl_b32 s37, s25, 1
    s_and_b32 s38, s24, 1
    s_add_u32 s40, s37, s38
    s_xor_b32 s41, s40, 1
    s_lshl_b32 s49, s23, 11
    s_lshl_b32 s37, s23, 4
    s_add_u32 s37, s37, 0
    v_lshrrev_b32 v24, 3, v2
    v_add_u32 v24, s37, v24
    v_bfe_u32 v25, v24, 1, 3
    v_and_b32 v26, 7, v2
    v_xor_b32 v25, v25, v26
    s_lshl_b32 s38, s20, 7
    v_add_u32 v24, s38, v24
    v_mul_u32_u24 v24, 1280, v24
    v_lshl_add_u32 v5, v25, 4, v24
    s_lshl_b32 s37, s23, 4
    s_add_u32 s37, s37, 8
    v_lshrrev_b32 v24, 3, v2
    v_add_u32 v24, s37, v24
    v_bfe_u32 v25, v24, 1, 3
    v_and_b32 v26, 7, v2
    v_xor_b32 v25, v25, v26
    s_lshl_b32 s38, s20, 7
    v_add_u32 v24, s38, v24
    v_mul_u32_u24 v24, 1280, v24
    v_lshl_add_u32 v11, v25, 4, v24
    s_waitcnt lgkmcnt(0)
    s_add_u32 s8, s56, 0
    s_addc_u32 s9, s57, 0
    s_mov_b32 s10, 2621440
    s_mov_b32 s11, 0x00020000
    s_add_u32 s12, s58, 0
    s_addc_u32 s13, s59, 0
    s_mov_b32 s14, 2457600
    s_mov_b32 s15, 0x00020000
    s_cmp_eq_u32 s22, 0
    s_mov_b32 s38, 3145728
    s_cselect_b32 s37, 0, s38
    s_mov_b32 s38, 6291456
    s_cselect_b32 s18, 3145728, s38
    s_add_u32 s16, s4, s37
    s_addc_u32 s17, s5, 0
    s_mov_b32 s19, 0x00020000
    s_cmp_eq_u32 s22, 2
    s_cbranch_scc1 L_qa_cform
    s_cmp_eq_u32 s25, 0
    s_cbranch_scc0 L_qa_t1
    s_mov_b32 s48, 0
    s_mov_b32 s34, 0
    s_add_u32 m0, s49, 0
    s_nop 0
    buffer_load_dwordx4 v5, s[8:11], s48 offen lds
    s_add_u32 m0, s49, 1024
    s_nop 0
    buffer_load_dwordx4 v11, s[8:11], s48 offen lds
    s_add_u32 s48, s48, 128
    s_add_u32 m0, s28, 32768
    s_nop 0
    buffer_load_dwordx4 v4, s[12:15], s34 offen lds
    s_add_u32 s34, s34, s33
    s_add_u32 m0, s28, 40960
    s_nop 0
    buffer_load_dwordx4 v4, s[12:15], s34 offen lds
    s_add_u32 s34, s34, s33
    s_add_u32 m0, s49, 16384
    s_nop 0
    buffer_load_dwordx4 v5, s[8:11], s48 offen lds
    s_add_u32 m0, s49, 17408
    s_nop 0
    buffer_load_dwordx4 v11, s[8:11], s48 offen lds
    s_add_u32 s48, s48, 128
    s_add_u32 m0, s28, 49152
    s_nop 0
    buffer_load_dwordx4 v4, s[12:15], s34 offen lds
    s_add_u32 s34, s34, s33
    s_add_u32 m0, s28, 57344
    s_nop 0
    buffer_load_dwordx4 v4, s[12:15], s34 offen lds
    s_add_u32 s34, s34, s33
    s_lshl_b32 s37, s24, 5
    v_add_u32 v24, s37, v3
    v_bfe_u32 v25, v24, 2, 2
    v_lshlrev_b32 v24, 6, v24
    v_add_u32 v26, 0, v1
    v_xor_b32 v26, v26, v25
    v_lshl_add_u32 v8, v26, 4, v24
    v_add_u32 v26, 2, v1
    v_xor_b32 v26, v26, v25
    v_lshl_add_u32 v9, v26, 4, v24
    v_bfe_u32 v24, v2, 2, 2
    v_lshl_add_u32 v27, v1, 3, v24
    v_mul_u32_u24 v27, 256, v27
    v_and_b32 v25, 3, v2
    v_lshl_add_u32 v27, v25, 3, v27
    v_bfe_u32 v25, v2, 4, 1
    v_lshl_add_u32 v27, v25, 5, v27
    v_xor_b32 v26, s40, v24
    v_lshl_add_u32 v6, v26, 6, v27
    v_add_u32 v6, 32768, v6
    v_xor_b32 v26, s41, v24
    v_lshl_add_u32 v7, v26, 6, v27
    v_add_u32 v7, 32768, v7
    s_lshl_b32 s37, s24, 5
    v_add_u32 v24, s37, v3
    v_bfe_u32 v25, v24, 1, 3
    v_lshlrev_b32 v24, 7, v24
    v_add_u32 v26, 0, v1
    v_xor_b32 v26, v26, v25
    v_lshl_add_u32 v8, v26, 4, v24
    v_add_u32 v26, 2, v1
    v_xor_b32 v26, v26, v25
    v_lshl_add_u32 v9, v26, 4, v24
    v_add_u32 v26, 4, v1
    v_xor_b32 v26, v26, v25
    v_lshl_add_u32 v14, v26, 4, v24
    v_add_u32 v26, 6, v1
    v_xor_b32 v26, v26, v25
    v_lshl_add_u32 v15, v26, 4, v24
    v_and_b32 v24, 15, v2
    v_lshrrev_b32 v25, 4, v2
    v_cmp_eq_u32 vcc, v24, v25
    v_mov_b32 v26, 0x3f803f80
    s_nop 0
    v_cndmask_b32 v20, 0, v26, vcc
    v_cndmask_b32 v21, 0, v26, vcc
    v_cndmask_b32 v22, 0, v26, vcc
    v_cndmask_b32 v23, 0, v26, vcc
    v_mov_b32 v32, 0
    v_mov_b32 v33, 0
    v_mov_b32 v34, 0
    v_mov_b32 v35, 0
    v_mov_b32 v16, 0
    v_mov_b32 v17, 0
    v_mov_b32 v18, 0
    v_mov_b32 v19, 0
    v_mov_b32 v40, 0
    v_mov_b32 v41, 0
    v_mov_b32 v42, 0
    v_mov_b32 v43, 0
    v_mov_b32 v44, 0
    v_mov_b32 v45, 0
    v_mov_b32 v46, 0
    v_mov_b32 v47, 0
    v_mov_b32 v48, 0
    v_mov_b32 v49, 0
    v_mov_b32 v50, 0
    v_mov_b32 v51, 0
    v_mov_b32 v52, 0
    v_mov_b32 v53, 0
    v_mov_b32 v54, 0
    v_mov_b32 v55, 0
    v_mov_b32 v56, 0
    v_mov_b32 v57, 0
    v_mov_b32 v58, 0
    v_mov_b32 v59, 0
    v_mov_b32 v60, 0
    v_mov_b32 v61, 0
    v_mov_b32 v62, 0
    v_mov_b32 v63, 0
    v_mov_b32 v64, 0
    v_mov_b32 v65, 0
    v_mov_b32 v66, 0
    v_mov_b32 v67, 0
    v_mov_b32 v68, 0
    v_mov_b32 v69, 0
    v_mov_b32 v70, 0
    v_mov_b32 v71, 0
    s_cmp_lt_u32 s24, 2
    s_cselect_b64 vcc, -1, 0
    s_mov_b32 s42, 0
    s_waitcnt vmcnt(5)
    s_barrier
    ds_read_b128 v[72:75], v8 offset:0
    ds_read_b64_tr_b16 v[80:81], v6 offset:0
    ds_read_b64_tr_b16 v[82:83], v6 offset:1024
    ds_read_b64_tr_b16 v[84:85], v7 offset:0
    ds_read_b64_tr_b16 v[86:87], v7 offset:1024
    ds_read_b128 v[76:79], v9 offset:0
    ds_read_b64_tr_b16 v[88:89], v6 offset:4096
    ds_read_b64_tr_b16 v[90:91], v6 offset:5120
    ds_read_b64_tr_b16 v[92:93], v7 offset:4096
    ds_read_b64_tr_b16 v[94:95], v7 offset:5120
L_qaa_loop:
    s_waitcnt lgkmcnt(0)
    s_waitcnt vmcnt(4)
    s_barrier
    ds_read_b128 v[96:99], v14 offset:0
    ds_read_b64_tr_b16 v[104:105], v6 offset:8192
    ds_read_b64_tr_b16 v[106:107], v6 offset:9216
    ds_read_b64_tr_b16 v[108:109], v7 offset:8192
    ds_read_b64_tr_b16 v[110:111], v7 offset:9216
    ds_read_b128 v[100:103], v15 offset:0
    ds_read_b64_tr_b16 v[112:113], v6 offset:12288
    ds_read_b64_tr_b16 v[114:115], v6 offset:13312
    ds_read_b64_tr_b16 v[116:117], v7 offset:12288
    ds_read_b64_tr_b16 v[118:119], v7 offset:13312
    v_mfma_f32_32x32x16_bf16 v[40:55], v[80:83], v[72:75], v[40:55]
    s_add_u32 m0, s28, 32768
    s_nop 0
    buffer_load_dwordx4 v4, s[12:15], s34 offen lds
    s_add_u32 s34, s34, s33
    v_lshlrev_b32 v36, 16, v72
    v_and_b32 v37, 0xffff0000, v72
    v_add_f32 v32, v32, v36
    v_add_f32 v33, v33, v37
    v_fmac_f32 v34, v36, v36
    v_fmac_f32 v35, v37, v37
    v_mfma_f32_32x32x16_bf16 v[56:71], v[84:87], v[72:75], v[56:71]
    v_lshlrev_b32 v38, 16, v73
    v_and_b32 v39, 0xffff0000, v73
    v_add_f32 v32, v32, v38
    v_add_f32 v33, v33, v39
    v_fmac_f32 v34, v38, v38
    v_fmac_f32 v35, v39, v39
    v_mfma_f32_32x32x16_bf16 v[40:55], v[88:91], v[76:79], v[40:55]
    v_lshlrev_b32 v36, 16, v76
    v_and_b32 v37, 0xffff0000, v76
    v_add_f32 v32, v32, v36
    v_add_f32 v33, v33, v37
    v_fmac_f32 v34, v36, v36
    v_fmac_f32 v35, v37, v37
    v_mfma_f32_32x32x16_bf16 v[56:71], v[92:95], v[76:79], v[56:71]
    v_lshlrev_b32 v38, 16, v77
    v_and_b32 v39, 0xffff0000, v77
    v_add_f32 v32, v32, v38
    v_add_f32 v33, v33, v39
    v_fmac_f32 v34, v38, v38
    v_fmac_f32 v35, v39, v39
    s_cbranch_vccz L_qaa_ns0
    v_mfma_f32_16x16x32_bf16 v[16:19], v[80:83], v[20:23], v[16:19]
    v_mfma_f32_16x16x32_bf16 v[16:19], v[88:91], v[20:23], v[16:19]
L_qaa_ns0:
    s_waitcnt lgkmcnt(0)
    s_waitcnt vmcnt(1)
    s_barrier
    ds_read_b128 v[72:75], v8 offset:16384
    ds_read_b64_tr_b16 v[80:81], v6 offset:16384
    ds_read_b64_tr_b16 v[82:83], v6 offset:17408
    ds_read_b64_tr_b16 v[84:85], v7 offset:16384
    ds_read_b64_tr_b16 v[86:87], v7 offset:17408
    ds_read_b128 v[76:79], v9 offset:16384
    ds_read_b64_tr_b16 v[88:89], v6 offset:20480
    ds_read_b64_tr_b16 v[90:91], v6 offset:21504
    ds_read_b64_tr_b16 v[92:93], v7 offset:20480
    ds_read_b64_tr_b16 v[94:95], v7 offset:21504
    v_mfma_f32_32x32x16_bf16 v[40:55], v[104:107], v[96:99], v[40:55]
    s_add_u32 m0, s49, 0
    s_nop 0
    buffer_load_dwordx4 v5, s[8:11], s48 offen lds
    v_lshlrev_b32 v36, 16, v96
    v_and_b32 v37, 0xffff0000, v96
    v_add_f32 v32, v32, v36
    v_add_f32 v33, v33, v37
    v_fmac_f32 v34, v36, v36
    v_fmac_f32 v35, v37, v37
    v_mfma_f32_32x32x16_bf16 v[56:71], v[108:111], v[96:99], v[56:71]
    s_add_u32 m0, s49, 1024
    s_nop 0
    buffer_load_dwordx4 v11, s[8:11], s48 offen lds
    s_add_u32 s48, s48, 128
    v_lshlrev_b32 v38, 16, v97
    v_and_b32 v39, 0xffff0000, v97
    v_add_f32 v32, v32, v38
    v_add_f32 v33, v33, v39
    v_fmac_f32 v34, v38, v38
    v_fmac_f32 v35, v39, v39
    v_mfma_f32_32x32x16_bf16 v[40:55], v[112:115], v[100:103], v[40:55]
    s_add_u32 m0, s28, 40960
    s_nop 0
    buffer_load_dwordx4 v4, s[12:15], s34 offen lds
    s_add_u32 s34, s34, s33
    v_lshlrev_b32 v36, 16, v100
    v_and_b32 v37, 0xffff0000, v100
    v_add_f32 v32, v32, v36
    v_add_f32 v33, v33, v37
    v_fmac_f32 v34, v36, v36
    v_fmac_f32 v35, v37, v37
    v_mfma_f32_32x32x16_bf16 v[56:71], v[116:119], v[100:103], v[56:71]
    v_lshlrev_b32 v38, 16, v101
    v_and_b32 v39, 0xffff0000, v101
    v_add_f32 v32, v32, v38
    v_add_f32 v33, v33, v39
    v_fmac_f32 v34, v38, v38
    v_fmac_f32 v35, v39, v39
    s_cbranch_vccz L_qaa_ns1
    v_mfma_f32_16x16x32_bf16 v[16:19], v[104:107], v[20:23], v[16:19]
    v_mfma_f32_16x16x32_bf16 v[16:19], v[112:115], v[20:23], v[16:19]
L_qaa_ns1:
    s_waitcnt lgkmcnt(0)
    s_waitcnt vmcnt(4)
    s_barrier
    ds_read_b128 v[96:99], v14 offset:16384
    ds_read_b64_tr_b16 v[104:105], v6 offset:24576
    ds_read_b64_tr_b16 v[106:107], v6 offset:25600
    ds_read_b64_tr_b16 v[108:109], v7 offset:24576
    ds_read_b64_tr_b16 v[110:111], v7 offset:25600
    ds_read_b128 v[100:103], v15 offset:16384
    ds_read_b64_tr_b16 v[112:113], v6 offset:28672
    ds_read_b64_tr_b16 v[114:115], v6 offset:29696
    ds_read_b64_tr_b16 v[116:117], v7 offset:28672
    ds_read_b64_tr_b16 v[118:119], v7 offset:29696
    v_mfma_f32_32x32x16_bf16 v[40:55], v[80:83], v[72:75], v[40:55]
    s_add_u32 m0, s28, 49152
    s_nop 0
    buffer_load_dwordx4 v4, s[12:15], s34 offen lds
    s_add_u32 s34, s34, s33
    v_lshlrev_b32 v36, 16, v72
    v_and_b32 v37, 0xffff0000, v72
    v_add_f32 v32, v32, v36
    v_add_f32 v33, v33, v37
    v_fmac_f32 v34, v36, v36
    v_fmac_f32 v35, v37, v37
    v_mfma_f32_32x32x16_bf16 v[56:71], v[84:87], v[72:75], v[56:71]
    v_lshlrev_b32 v38, 16, v73
    v_and_b32 v39, 0xffff0000, v73
    v_add_f32 v32, v32, v38
    v_add_f32 v33, v33, v39
    v_fmac_f32 v34, v38, v38
    v_fmac_f32 v35, v39, v39
    v_mfma_f32_32x32x16_bf16 v[40:55], v[88:91], v[76:79], v[40:55]
    v_lshlrev_b32 v36, 16, v76
    v_and_b32 v37, 0xffff0000, v76
    v_add_f32 v32, v32, v36
    v_add_f32 v33, v33, v37
    v_fmac_f32 v34, v36, v36
    v_fmac_f32 v35, v37, v37
    v_mfma_f32_32x32x16_bf16 v[56:71], v[92:95], v[76:79], v[56:71]
    v_lshlrev_b32 v38, 16, v77
    v_and_b32 v39, 0xffff0000, v77
    v_add_f32 v32, v32, v38
    v_add_f32 v33, v33, v39
    v_fmac_f32 v34, v38, v38
    v_fmac_f32 v35, v39, v39
    s_cbranch_vccz L_qaa_ns2
    v_mfma_f32_16x16x32_bf16 v[16:19], v[80:83], v[20:23], v[16:19]
    v_mfma_f32_16x16x32_bf16 v[16:19], v[88:91], v[20:23], v[16:19]
L_qaa_ns2:
    s_waitcnt lgkmcnt(0)
    s_waitcnt vmcnt(1)
    s_barrier
    ds_read_b128 v[72:75], v8 offset:0
    ds_read_b64_tr_b16 v[80:81], v6 offset:0
    ds_read_b64_tr_b16 v[82:83], v6 offset:1024
    ds_read_b64_tr_b16 v[84:85], v7 offset:0
    ds_read_b64_tr_b16 v[86:87], v7 offset:1024
    ds_read_b128 v[76:79], v9 offset:0
    ds_read_b64_tr_b16 v[88:89], v6 offset:4096
    ds_read_b64_tr_b16 v[90:91], v6 offset:5120
    ds_read_b64_tr_b16 v[92:93], v7 offset:4096
    ds_read_b64_tr_b16 v[94:95], v7 offset:5120
    v_mfma_f32_32x32x16_bf16 v[40:55], v[104:107], v[96:99], v[40:55]
    s_add_u32 m0, s49, 16384
    s_nop 0
    buffer_load_dwordx4 v5, s[8:11], s48 offen lds
    v_lshlrev_b32 v36, 16, v96
    v_and_b32 v37, 0xffff0000, v96
    v_add_f32 v32, v32, v36
    v_add_f32 v33, v33, v37
    v_fmac_f32 v34, v36, v36
    v_fmac_f32 v35, v37, v37
    v_mfma_f32_32x32x16_bf16 v[56:71], v[108:111], v[96:99], v[56:71]
    s_add_u32 m0, s49, 17408
    s_nop 0
    buffer_load_dwordx4 v11, s[8:11], s48 offen lds
    s_add_u32 s48, s48, 128
    v_lshlrev_b32 v38, 16, v97
    v_and_b32 v39, 0xffff0000, v97
    v_add_f32 v32, v32, v38
    v_add_f32 v33, v33, v39
    v_fmac_f32 v34, v38, v38
    v_fmac_f32 v35, v39, v39
    v_mfma_f32_32x32x16_bf16 v[40:55], v[112:115], v[100:103], v[40:55]
    s_add_u32 m0, s28, 57344
    s_nop 0
    buffer_load_dwordx4 v4, s[12:15], s34 offen lds
    s_add_u32 s34, s34, s33
    v_lshlrev_b32 v36, 16, v100
    v_and_b32 v37, 0xffff0000, v100
    v_add_f32 v32, v32, v36
    v_add_f32 v33, v33, v37
    v_fmac_f32 v34, v36, v36
    v_fmac_f32 v35, v37, v37
    v_mfma_f32_32x32x16_bf16 v[56:71], v[116:119], v[100:103], v[56:71]
    v_lshlrev_b32 v38, 16, v101
    v_and_b32 v39, 0xffff0000, v101
    v_add_f32 v32, v32, v38
    v_add_f32 v33, v33, v39
    v_fmac_f32 v34, v38, v38
    v_fmac_f32 v35, v39, v39
    s_cbranch_vccz L_qaa_ns3
    v_mfma_f32_16x16x32_bf16 v[16:19], v[104:107], v[20:23], v[16:19]
    v_mfma_f32_16x16x32_bf16 v[16:19], v[112:115], v[20:23], v[16:19]
L_qaa_ns3:
    s_add_u32 s42, s42, 1
    s_cmp_lt_u32 s42, 4
    s_cbranch_scc1 L_qaa_loop
    s_waitcnt lgkmcnt(0)
    s_waitcnt vmcnt(3)
    s_barrier
    ds_read_b128 v[96:99], v14 offset:0
    ds_read_b64_tr_b16 v[104:105], v6 offset:8192
    ds_read_b64_tr_b16 v[106:107], v6 offset:9216
    ds_read_b64_tr_b16 v[108:109], v7 offset:8192
    ds_read_b64_tr_b16 v[110:111], v7 offset:9216
    ds_read_b128 v[100:103], v15 offset:0
    ds_read_b64_tr_b16 v[112:113], v6 offset:12288
    ds_read_b64_tr_b16 v[114:115], v6 offset:13312
    ds_read_b64_tr_b16 v[116:117], v7 offset:12288
    ds_read_b64_tr_b16 v[118:119], v7 offset:13312
    v_mfma_f32_32x32x16_bf16 v[40:55], v[80:83], v[72:75], v[40:55]
    v_lshlrev_b32 v36, 16, v72
    v_and_b32 v37, 0xffff0000, v72
    v_add_f32 v32, v32, v36
    v_add_f32 v33, v33, v37
    v_fmac_f32 v34, v36, v36
    v_fmac_f32 v35, v37, v37
    v_mfma_f32_32x32x16_bf16 v[56:71], v[84:87], v[72:75], v[56:71]
    v_lshlrev_b32 v38, 16, v73
    v_and_b32 v39, 0xffff0000, v73
    v_add_f32 v32, v32, v38
    v_add_f32 v33, v33, v39
    v_fmac_f32 v34, v38, v38
    v_fmac_f32 v35, v39, v39
    v_mfma_f32_32x32x16_bf16 v[40:55], v[88:91], v[76:79], v[40:55]
    v_lshlrev_b32 v36, 16, v76
    v_and_b32 v37, 0xffff0000, v76
    v_add_f32 v32, v32, v36
    v_add_f32 v33, v33, v37
    v_fmac_f32 v34, v36, v36
    v_fmac_f32 v35, v37, v37
    v_mfma_f32_32x32x16_bf16 v[56:71], v[92:95], v[76:79], v[56:71]
    v_lshlrev_b32 v38, 16, v77
    v_and_b32 v39, 0xffff0000, v77
    v_add_f32 v32, v32, v38
    v_add_f32 v33, v33, v39
    v_fmac_f32 v34, v38, v38
    v_fmac_f32 v35, v39, v39
    s_cbranch_vccz L_qaa_ns16
    v_mfma_f32_16x16x32_bf16 v[16:19], v[80:83], v[20:23], v[16:19]
    v_mfma_f32_16x16x32_bf16 v[16:19], v[88:91], v[20:23], v[16:19]
L_qaa_ns16:
    s_waitcnt lgkmcnt(0)
    s_waitcnt vmcnt(0)
    s_barrier
    ds_read_b128 v[72:75], v8 offset:16384
    ds_read_b64_tr_b16 v[80:81], v6 offset:16384
    ds_read_b64_tr_b16 v[82:83], v6 offset:17408
    ds_read_b64_tr_b16 v[84:85], v7 offset:16384
    ds_read_b64_tr_b16 v[86:87], v7 offset:17408
    ds_read_b128 v[76:79], v9 offset:16384
    ds_read_b64_tr_b16 v[88:89], v6 offset:20480
    ds_read_b64_tr_b16 v[90:91], v6 offset:21504
    ds_read_b64_tr_b16 v[92:93], v7 offset:20480
    ds_read_b64_tr_b16 v[94:95], v7 offset:21504
    v_mfma_f32_32x32x16_bf16 v[40:55], v[104:107], v[96:99], v[40:55]
    v_lshlrev_b32 v36, 16, v96
    v_and_b32 v37, 0xffff0000, v96
    v_add_f32 v32, v32, v36
    v_add_f32 v33, v33, v37
    v_fmac_f32 v34, v36, v36
    v_fmac_f32 v35, v37, v37
    v_mfma_f32_32x32x16_bf16 v[56:71], v[108:111], v[96:99], v[56:71]
    v_lshlrev_b32 v38, 16, v97
    v_and_b32 v39, 0xffff0000, v97
    v_add_f32 v32, v32, v38
    v_add_f32 v33, v33, v39
    v_fmac_f32 v34, v38, v38
    v_fmac_f32 v35, v39, v39
    v_mfma_f32_32x32x16_bf16 v[40:55], v[112:115], v[100:103], v[40:55]
    v_lshlrev_b32 v36, 16, v100
    v_and_b32 v37, 0xffff0000, v100
    v_add_f32 v32, v32, v36
    v_add_f32 v33, v33, v37
    v_fmac_f32 v34, v36, v36
    v_fmac_f32 v35, v37, v37
    v_mfma_f32_32x32x16_bf16 v[56:71], v[116:119], v[100:103], v[56:71]
    v_lshlrev_b32 v38, 16, v101
    v_and_b32 v39, 0xffff0000, v101
    v_add_f32 v32, v32, v38
    v_add_f32 v33, v33, v39
    v_fmac_f32 v34, v38, v38
    v_fmac_f32 v35, v39, v39
    s_cbranch_vccz L_qaa_ns17
    v_mfma_f32_16x16x32_bf16 v[16:19], v[104:107], v[20:23], v[16:19]
    v_mfma_f32_16x16x32_bf16 v[16:19], v[112:115], v[20:23], v[16:19]
L_qaa_ns17:
    s_waitcnt lgkmcnt(0)
    s_waitcnt vmcnt(0)
    s_barrier
    ds_read_b128 v[96:99], v14 offset:16384
    ds_read_b64_tr_b16 v[104:105], v6 offset:24576
    ds_read_b64_tr_b16 v[106:107], v6 offset:25600
    ds_read_b64_tr_b16 v[108:109], v7 offset:24576
    ds_read_b64_tr_b16 v[110:111], v7 offset:25600
    ds_read_b128 v[100:103], v15 offset:16384
    ds_read_b64_tr_b16 v[112:113], v6 offset:28672
    ds_read_b64_tr_b16 v[114:115], v6 offset:29696
    ds_read_b64_tr_b16 v[116:117], v7 offset:28672
    ds_read_b64_tr_b16 v[118:119], v7 offset:29696
    v_mfma_f32_32x32x16_bf16 v[40:55], v[80:83], v[72:75], v[40:55]
    v_lshlrev_b32 v36, 16, v72
    v_and_b32 v37, 0xffff0000, v72
    v_add_f32 v32, v32, v36
    v_add_f32 v33, v33, v37
    v_fmac_f32 v34, v36, v36
    v_fmac_f32 v35, v37, v37
    v_mfma_f32_32x32x16_bf16 v[56:71], v[84:87], v[72:75], v[56:71]
    v_lshlrev_b32 v38, 16, v73
    v_and_b32 v39, 0xffff0000, v73
    v_add_f32 v32, v32, v38
    v_add_f32 v33, v33, v39
    v_fmac_f32 v34, v38, v38
    v_fmac_f32 v35, v39, v39
    v_mfma_f32_32x32x16_bf16 v[40:55], v[88:91], v[76:79], v[40:55]
    v_lshlrev_b32 v36, 16, v76
    v_and_b32 v37, 0xffff0000, v76
    v_add_f32 v32, v32, v36
    v_add_f32 v33, v33, v37
    v_fmac_f32 v34, v36, v36
    v_fmac_f32 v35, v37, v37
    v_mfma_f32_32x32x16_bf16 v[56:71], v[92:95], v[76:79], v[56:71]
    v_lshlrev_b32 v38, 16, v77
    v_and_b32 v39, 0xffff0000, v77
    v_add_f32 v32, v32, v38
    v_add_f32 v33, v33, v39
    v_fmac_f32 v34, v38, v38
    v_fmac_f32 v35, v39, v39
    s_cbranch_vccz L_qaa_ns18
    v_mfma_f32_16x16x32_bf16 v[16:19], v[80:83], v[20:23], v[16:19]
    v_mfma_f32_16x16x32_bf16 v[16:19], v[88:91], v[20:23], v[16:19]
L_qaa_ns18:
    s_waitcnt lgkmcnt(0)
    v_mfma_f32_32x32x16_bf16 v[40:55], v[104:107], v[96:99], v[40:55]
    v_lshlrev_b32 v36, 16, v96
    v_and_b32 v37, 0xffff0000, v96
    v_add_f32 v32, v32, v36
    v_add_f32 v33, v33, v37
    v_fmac_f32 v34, v36, v36
    v_fmac_f32 v35, v37, v37
    v_mfma_f32_32x32x16_bf16 v[56:71], v[108:111], v[96:99], v[56:71]
    v_lshlrev_b32 v38, 16, v97
    v_and_b32 v39, 0xffff0000, v97
    v_add_f32 v32, v32, v38
    v_add_f32 v33, v33, v39
    v_fmac_f32 v34, v38, v38
    v_fmac_f32 v35, v39, v39
    v_mfma_f32_32x32x16_bf16 v[40:55], v[112:115], v[100:103], v[40:55]
    v_lshlrev_b32 v36, 16, v100
    v_and_b32 v37, 0xffff0000, v100
    v_add_f32 v32, v32, v36
    v_add_f32 v33, v33, v37
    v_fmac_f32 v34, v36, v36
    v_fmac_f32 v35, v37, v37
    v_mfma_f32_32x32x16_bf16 v[56:71], v[116:119], v[100:103], v[56:71]
    v_lshlrev_b32 v38, 16, v101
    v_and_b32 v39, 0xffff0000, v101
    v_add_f32 v32, v32, v38
    v_add_f32 v33, v33, v39
    v_fmac_f32 v34, v38, v38
    v_fmac_f32 v35, v39, v39
    s_cbranch_vccz L_qaa_ns19
    v_mfma_f32_16x16x32_bf16 v[16:19], v[104:107], v[20:23], v[16:19]
    v_mfma_f32_16x16x32_bf16 v[16:19], v[112:115], v[20:23], v[16:19]
L_qaa_ns19:
    s_branch L_qa_post
L_qa_t1:
    s_mov_b32 s48, 0
    s_mov_b32 s34, 0
    s_add_u32 m0, s49, 0
    s_nop 0
    buffer_load_dwordx4 v5, s[8:11], s48 offen lds
    s_add_u32 m0, s49, 1024
    s_nop 0
    buffer_load_dwordx4 v11, s[8:11], s48 offen lds
    s_add_u32 s48, s48, 128
    s_add_u32 m0, s28, 32768
    s_nop 0
    buffer_load_dwordx4 v4, s[12:15], s34 offen lds
    s_add_u32 s34, s34, s33
    s_add_u32 m0, s28, 40960
    s_nop 0
    buffer_load_dwordx4 v4, s[12:15], s34 offen lds
    s_add_u32 s34, s34, s33
    s_add_u32 m0, s49, 16384
    s_nop 0
    buffer_load_dwordx4 v5, s[8:11], s48 offen lds
    s_add_u32 m0, s49, 17408
    s_nop 0
    buffer_load_dwordx4 v11, s[8:11], s48 offen lds
    s_add_u32 s48, s48, 128
    s_add_u32 m0, s28, 49152
    s_nop 0
    buffer_load_dwordx4 v4, s[12:15], s34 offen lds
    s_add_u32 s34, s34, s33
    s_add_u32 m0, s28, 57344
    s_nop 0
    buffer_load_dwordx4 v4, s[12:15], s34 offen lds
    s_add_u32 s34, s34, s33
    s_lshl_b32 s37, s24, 5
    v_add_u32 v24, s37, v3
    v_bfe_u32 v25, v24, 2, 2
    v_lshlrev_b32 v24, 6, v24
    v_add_u32 v26, 0, v1
    v_xor_b32 v26, v26, v25
    v_lshl_add_u32 v8, v26, 4, v24
    v_add_u32 v26, 2, v1
    v_xor_b32 v26, v26, v25
    v_lshl_add_u32 v9, v26, 4, v24
    v_bfe_u32 v24, v2, 2, 2
    v_lshl_add_u32 v27, v1, 3, v24
    v_mul_u32_u24 v27, 256, v27
    v_and_b32 v25, 3, v2
    v_lshl_add_u32 v27, v25, 3, v27
    v_bfe_u32 v25, v2, 4, 1
    v_lshl_add_u32 v27, v25, 5, v27
    v_xor_b32 v26, s40, v24
    v_lshl_add_u32 v6, v26, 6, v27
    v_add_u32 v6, 32768, v6
    v_xor_b32 v26, s41, v24
    v_lshl_add_u32 v7, v26, 6, v27
    v_add_u32 v7, 32768, v7
    s_lshl_b32 s37, s24, 5
    v_add_u32 v24, s37, v3
    v_bfe_u32 v25, v24, 1, 3
    v_lshlrev_b32 v24, 7, v24
    v_add_u32 v26, 0, v1
    v_xor_b32 v26, v26, v25
    v_lshl_add_u32 v8, v26, 4, v24
    v_add_u32 v26, 2, v1
    v_xor_b32 v26, v26, v25
    v_lshl_add_u32 v9, v26, 4, v24
    v_add_u32 v26, 4, v1
    v_xor_b32 v26, v26, v25
    v_lshl_add_u32 v14, v26, 4, v24
    v_add_u32 v26, 6, v1
    v_xor_b32 v26, v26, v25
    v_lshl_add_u32 v15, v26, 4, v24
    v_and_b32 v24, 15, v2
    v_lshrrev_b32 v25, 4, v2
    v_cmp_eq_u32 vcc, v24, v25
    v_mov_b32 v26, 0x3f803f80
    s_nop 0
    v_cndmask_b32 v20, 0, v26, vcc
    v_cndmask_b32 v21, 0, v26, vcc
    v_cndmask_b32 v22, 0, v26, vcc
    v_cndmask_b32 v23, 0, v26, vcc
    v_mov_b32 v32, 0
    v_mov_b32 v33, 0
    v_mov_b32 v34, 0
    v_mov_b32 v35, 0
    v_mov_b32 v16, 0
    v_mov_b32 v17, 0
    v_mov_b32 v18, 0
    v_mov_b32 v19, 0
    v_mov_b32 v40, 0
    v_mov_b32 v41, 0
    v_mov_b32 v42, 0
    v_mov_b32 v43, 0
    v_mov_b32 v44, 0
    v_mov_b32 v45, 0
    v_mov_b32 v46, 0
    v_mov_b32 v47, 0
    v_mov_b32 v48, 0
    v_mov_b32 v49, 0
    v_mov_b32 v50, 0
    v_mov_b32 v51, 0
    v_mov_b32 v52, 0
    v_mov_b32 v53, 0
    v_mov_b32 v54, 0
    v_mov_b32 v55, 0
    v_mov_b32 v56, 0
    v_mov_b32 v57, 0
    v_mov_b32 v58, 0
    v_mov_b32 v59, 0
    v_mov_b32 v60, 0
    v_mov_b32 v61, 0
    v_mov_b32 v62, 0
    v_mov_b32 v63, 0
    v_mov_b32 v64, 0
    v_mov_b32 v65, 0
    v_mov_b32 v66, 0
    v_mov_b32 v67, 0
    v_mov_b32 v68, 0
    v_mov_b32 v69, 0
    v_mov_b32 v70, 0
    v_mov_b32 v71, 0
    s_cmp_lt_u32 s24, 2
    s_cselect_b64 vcc, -1, 0
    s_mov_b32 s42, 0
    s_waitcnt vmcnt(5)
    s_barrier
    ds_read_b128 v[72:75], v8 offset:0
    ds_read_b64_tr_b16 v[80:81], v6 offset:0
    ds_read_b64_tr_b16 v[82:83], v6 offset:1024
    ds_read_b64_tr_b16 v[84:85], v7 offset:0
    ds_read_b64_tr_b16 v[86:87], v7 offset:1024
    ds_read_b128 v[76:79], v9 offset:0
    ds_read_b64_tr_b16 v[88:89], v6 offset:4096
    ds_read_b64_tr_b16 v[90:91], v6 offset:5120
    ds_read_b64_tr_b16 v[92:93], v7 offset:4096
    ds_read_b64_tr_b16 v[94:95], v7 offset:5120
L_qab_loop:
    s_waitcnt lgkmcnt(0)
    s_waitcnt vmcnt(4)
    s_barrier
    ds_read_b128 v[96:99], v14 offset:0
    ds_read_b64_tr_b16 v[104:105], v6 offset:8192
    ds_read_b64_tr_b16 v[106:107], v6 offset:9216
    ds_read_b64_tr_b16 v[108:109], v7 offset:8192
    ds_read_b64_tr_b16 v[110:111], v7 offset:9216
    ds_read_b128 v[100:103], v15 offset:0
    ds_read_b64_tr_b16 v[112:113], v6 offset:12288
    ds_read_b64_tr_b16 v[114:115], v6 offset:13312
    ds_read_b64_tr_b16 v[116:117], v7 offset:12288
    ds_read_b64_tr_b16 v[118:119], v7 offset:13312
    v_mfma_f32_32x32x16_bf16 v[40:55], v[80:83], v[72:75], v[40:55]
    s_add_u32 m0, s28, 32768
    s_nop 0
    buffer_load_dwordx4 v4, s[12:15], s34 offen lds
    s_add_u32 s34, s34, s33
    v_lshlrev_b32 v36, 16, v74
    v_and_b32 v37, 0xffff0000, v74
    v_add_f32 v32, v32, v36
    v_add_f32 v33, v33, v37
    v_fmac_f32 v34, v36, v36
    v_fmac_f32 v35, v37, v37
    v_mfma_f32_32x32x16_bf16 v[56:71], v[84:87], v[72:75], v[56:71]
    v_lshlrev_b32 v38, 16, v75
    v_and_b32 v39, 0xffff0000, v75
    v_add_f32 v32, v32, v38
    v_add_f32 v33, v33, v39
    v_fmac_f32 v34, v38, v38
    v_fmac_f32 v35, v39, v39
    v_mfma_f32_32x32x16_bf16 v[40:55], v[88:91], v[76:79], v[40:55]
    v_lshlrev_b32 v36, 16, v78
    v_and_b32 v37, 0xffff0000, v78
    v_add_f32 v32, v32, v36
    v_add_f32 v33, v33, v37
    v_fmac_f32 v34, v36, v36
    v_fmac_f32 v35, v37, v37
    v_mfma_f32_32x32x16_bf16 v[56:71], v[92:95], v[76:79], v[56:71]
    v_lshlrev_b32 v38, 16, v79
    v_and_b32 v39, 0xffff0000, v79
    v_add_f32 v32, v32, v38
    v_add_f32 v33, v33, v39
    v_fmac_f32 v34, v38, v38
    v_fmac_f32 v35, v39, v39
    s_cbranch_vccz L_qab_ns0
    v_mfma_f32_16x16x32_bf16 v[16:19], v[80:83], v[20:23], v[16:19]
    v_mfma_f32_16x16x32_bf16 v[16:19], v[88:91], v[20:23], v[16:19]
L_qab_ns0:
    s_waitcnt lgkmcnt(0)
    s_waitcnt vmcnt(1)
    s_barrier
    ds_read_b128 v[72:75], v8 offset:16384
    ds_read_b64_tr_b16 v[80:81], v6 offset:16384
    ds_read_b64_tr_b16 v[82:83], v6 offset:17408
    ds_read_b64_tr_b16 v[84:85], v7 offset:16384
    ds_read_b64_tr_b16 v[86:87], v7 offset:17408
    ds_read_b128 v[76:79], v9 offset:16384
    ds_read_b64_tr_b16 v[88:89], v6 offset:20480
    ds_read_b64_tr_b16 v[90:91], v6 offset:21504
    ds_read_b64_tr_b16 v[92:93], v7 offset:20480
    ds_read_b64_tr_b16 v[94:95], v7 offset:21504
    v_mfma_f32_32x32x16_bf16 v[40:55], v[104:107], v[96:99], v[40:55]
    s_add_u32 m0, s49, 0
    s_nop 0
    buffer_load_dwordx4 v5, s[8:11], s48 offen lds
    v_lshlrev_b32 v36, 16, v98
    v_and_b32 v37, 0xffff0000, v98
    v_add_f32 v32, v32, v36
    v_add_f32 v33, v33, v37
    v_fmac_f32 v34, v36, v36
    v_fmac_f32 v35, v37, v37
    v_mfma_f32_32x32x16_bf16 v[56:71], v[108:111], v[96:99], v[56:71]
    s_add_u32 m0, s49, 1024
    s_nop 0
    buffer_load_dwordx4 v11, s[8:11], s48 offen lds
    s_add_u32 s48, s48, 128
    v_lshlrev_b32 v38, 16, v99
    v_and_b32 v39, 0xffff0000, v99
    v_add_f32 v32, v32, v38
    v_add_f32 v33, v33, v39
    v_fmac_f32 v34, v38, v38
    v_fmac_f32 v35, v39, v39
    v_mfma_f32_32x32x16_bf16 v[40:55], v[112:115], v[100:103], v[40:55]
    s_add_u32 m0, s28, 40960
    s_nop 0
    buffer_load_dwordx4 v4, s[12:15], s34 offen lds
    s_add_u32 s34, s34, s33
    v_lshlrev_b32 v36, 16, v102
    v_and_b32 v37, 0xffff0000, v102
    v_add_f32 v32, v32, v36
    v_add_f32 v33, v33, v37
    v_fmac_f32 v34, v36, v36
    v_fmac_f32 v35, v37, v37
    v_mfma_f32_32x32x16_bf16 v[56:71], v[116:119], v[100:103], v[56:71]
    v_lshlrev_b32 v38, 16, v103
    v_and_b32 v39, 0xffff0000, v103
    v_add_f32 v32, v32, v38
    v_add_f32 v33, v33, v39
    v_fmac_f32 v34, v38, v38
    v_fmac_f32 v35, v39, v39
    s_cbranch_vccz L_qab_ns1
    v_mfma_f32_16x16x32_bf16 v[16:19], v[104:107], v[20:23], v[16:19]
    v_mfma_f32_16x16x32_bf16 v[16:19], v[112:115], v[20:23], v[16:19]
L_qab_ns1:
    s_waitcnt lgkmcnt(0)
    s_waitcnt vmcnt(4)
    s_barrier
    ds_read_b128 v[96:99], v14 offset:16384
    ds_read_b64_tr_b16 v[104:105], v6 offset:24576
    ds_read_b64_tr_b16 v[106:107], v6 offset:25600
    ds_read_b64_tr_b16 v[108:109], v7 offset:24576
    ds_read_b64_tr_b16 v[110:111], v7 offset:25600
    ds_read_b128 v[100:103], v15 offset:16384
    ds_read_b64_tr_b16 v[112:113], v6 offset:28672
    ds_read_b64_tr_b16 v[114:115], v6 offset:29696
    ds_read_b64_tr_b16 v[116:117], v7 offset:28672
    ds_read_b64_tr_b16 v[118:119], v7 offset:29696
    v_mfma_f32_32x32x16_bf16 v[40:55], v[80:83], v[72:75], v[40:55]
    s_add_u32 m0, s28, 49152
    s_nop 0
    buffer_load_dwordx4 v4, s[12:15], s34 offen lds
    s_add_u32 s34, s34, s33
    v_lshlrev_b32 v36, 16, v74
    v_and_b32 v37, 0xffff0000, v74
    v_add_f32 v32, v32, v36
    v_add_f32 v33, v33, v37
    v_fmac_f32 v34, v36, v36
    v_fmac_f32 v35, v37, v37
    v_mfma_f32_32x32x16_bf16 v[56:71], v[84:87], v[72:75], v[56:71]
    v_lshlrev_b32 v38, 16, v75
    v_and_b32 v39, 0xffff0000, v75
    v_add_f32 v32, v32, v38
    v_add_f32 v33, v33, v39
    v_fmac_f32 v34, v38, v38
    v_fmac_f32 v35, v39, v39
    v_mfma_f32_32x32x16_bf16 v[40:55], v[88:91], v[76:79], v[40:55]
    v_lshlrev_b32 v36, 16, v78
    v_and_b32 v37, 0xffff0000, v78
    v_add_f32 v32, v32, v36
    v_add_f32 v33, v33, v37
    v_fmac_f32 v34, v36, v36
    v_fmac_f32 v35, v37, v37
    v_mfma_f32_32x32x16_bf16 v[56:71], v[92:95], v[76:79], v[56:71]
    v_lshlrev_b32 v38, 16, v79
    v_and_b32 v39, 0xffff0000, v79
    v_add_f32 v32, v32, v38
    v_add_f32 v33, v33, v39
    v_fmac_f32 v34, v38, v38
    v_fmac_f32 v35, v39, v39
    s_cbranch_vccz L_qab_ns2
    v_mfma_f32_16x16x32_bf16 v[16:19], v[80:83], v[20:23], v[16:19]
    v_mfma_f32_16x16x32_bf16 v[16:19], v[88:91], v[20:23], v[16:19]
L_qab_ns2:
    s_waitcnt lgkmcnt(0)
    s_waitcnt vmcnt(1)
    s_barrier
    ds_read_b128 v[72:75], v8 offset:0
    ds_read_b64_tr_b16 v[80:81], v6 offset:0
    ds_read_b64_tr_b16 v[82:83], v6 offset:1024
    ds_read_b64_tr_b16 v[84:85], v7 offset:0
    ds_read_b64_tr_b16 v[86:87], v7 offset:1024
    ds_read_b128 v[76:79], v9 offset:0
    ds_read_b64_tr_b16 v[88:89], v6 offset:4096
    ds_read_b64_tr_b16 v[90:91], v6 offset:5120
    ds_read_b64_tr_b16 v[92:93], v7 offset:4096
    ds_read_b64_tr_b16 v[94:95], v7 offset:5120
    v_mfma_f32_32x32x16_bf16 v[40:55], v[104:107], v[96:99], v[40:55]
    s_add_u32 m0, s49, 16384
    s_nop 0
    buffer_load_dwordx4 v5, s[8:11], s48 offen lds
    v_lshlrev_b32 v36, 16, v98
    v_and_b32 v37, 0xffff0000, v98
    v_add_f32 v32, v32, v36
    v_add_f32 v33, v33, v37
    v_fmac_f32 v34, v36, v36
    v_fmac_f32 v35, v37, v37
    v_mfma_f32_32x32x16_bf16 v[56:71], v[108:111], v[96:99], v[56:71]
    s_add_u32 m0, s49, 17408
    s_nop 0
    buffer_load_dwordx4 v11, s[8:11], s48 offen lds
    s_add_u32 s48, s48, 128
    v_lshlrev_b32 v38, 16, v99
    v_and_b32 v39, 0xffff0000, v99
    v_add_f32 v32, v32, v38
    v_add_f32 v33, v33, v39
    v_fmac_f32 v34, v38, v38
    v_fmac_f32 v35, v39, v39
    v_mfma_f32_32x32x16_bf16 v[40:55], v[112:115], v[100:103], v[40:55]
    s_add_u32 m0, s28, 57344
    s_nop 0
    buffer_load_dwordx4 v4, s[12:15], s34 offen lds
    s_add_u32 s34, s34, s33
    v_lshlrev_b32 v36, 16, v102
    v_and_b32 v37, 0xffff0000, v102
    v_add_f32 v32, v32, v36
    v_add_f32 v33, v33, v37
    v_fmac_f32 v34, v36, v36
    v_fmac_f32 v35, v37, v37
    v_mfma_f32_32x32x16_bf16 v[56:71], v[116:119], v[100:103], v[56:71]
    v_lshlrev_b32 v38, 16, v103
    v_and_b32 v39, 0xffff0000, v103
    v_add_f32 v32, v32, v38
    v_add_f32 v33, v33, v39
    v_fmac_f32 v34, v38, v38
    v_fmac_f32 v35, v39, v39
    s_cbranch_vccz L_qab_ns3
    v_mfma_f32_16x16x32_bf16 v[16:19], v[104:107], v[20:23], v[16:19]
    v_mfma_f32_16x16x32_bf16 v[16:19], v[112:115], v[20:23], v[16:19]
L_qab_ns3:
    s_add_u32 s42, s42, 1
    s_cmp_lt_u32 s42, 4
    s_cbranch_scc1 L_qab_loop
    s_waitcnt lgkmcnt(0)
    s_waitcnt vmcnt(3)
    s_barrier
    ds_read_b128 v[96:99], v14 offset:0
    ds_read_b64_tr_b16 v[104:105], v6 offset:8192
    ds_read_b64_tr_b16 v[106:107], v6 offset:9216
    ds_read_b64_tr_b16 v[108:109], v7 offset:8192
    ds_read_b64_tr_b16 v[110:111], v7 offset:9216
    ds_read_b128 v[100:103], v15 offset:0
    ds_read_b64_tr_b16 v[112:113], v6 offset:12288
    ds_read_b64_tr_b16 v[114:115], v6 offset:13312
    ds_read_b64_tr_b16 v[116:117], v7 offset:12288
    ds_read_b64_tr_b16 v[118:119], v7 offset:13312
    v_mfma_f32_32x32x16_bf16 v[40:55], v[80:83], v[72:75], v[40:55]
    v_lshlrev_b32 v36, 16, v74
    v_and_b32 v37, 0xffff0000, v74
    v_add_f32 v32, v32, v36
    v_add_f32 v33, v33, v37
    v_fmac_f32 v34, v36, v36
    v_fmac_f32 v35, v37, v37
    v_mfma_f32_32x32x16_bf16 v[56:71], v[84:87], v[72:75], v[56:71]
    v_lshlrev_b32 v38, 16, v75
    v_and_b32 v39, 0xffff0000, v75
    v_add_f32 v32, v32, v38
    v_add_f32 v33, v33, v39
    v_fmac_f32 v34, v38, v38
    v_fmac_f32 v35, v39, v39
    v_mfma_f32_32x32x16_bf16 v[40:55], v[88:91], v[76:79], v[40:55]
    v_lshlrev_b32 v36, 16, v78
    v_and_b32 v37, 0xffff0000, v78
    v_add_f32 v32, v32, v36
    v_add_f32 v33, v33, v37
    v_fmac_f32 v34, v36, v36
    v_fmac_f32 v35, v37, v37
    v_mfma_f32_32x32x16_bf16 v[56:71], v[92:95], v[76:79], v[56:71]
    v_lshlrev_b32 v38, 16, v79
    v_and_b32 v39, 0xffff0000, v79
    v_add_f32 v32, v32, v38
    v_add_f32 v33, v33, v39
    v_fmac_f32 v34, v38, v38
    v_fmac_f32 v35, v39, v39
    s_cbranch_vccz L_qab_ns16
    v_mfma_f32_16x16x32_bf16 v[16:19], v[80:83], v[20:23], v[16:19]
    v_mfma_f32_16x16x32_bf16 v[16:19], v[88:91], v[20:23], v[16:19]
L_qab_ns16:
    s_waitcnt lgkmcnt(0)
    s_waitcnt vmcnt(0)
    s_barrier
    ds_read_b128 v[72:75], v8 offset:16384
    ds_read_b64_tr_b16 v[80:81], v6 offset:16384
    ds_read_b64_tr_b16 v[82:83], v6 offset:17408
    ds_read_b64_tr_b16 v[84:85], v7 offset:16384
    ds_read_b64_tr_b16 v[86:87], v7 offset:17408
    ds_read_b128 v[76:79], v9 offset:16384
    ds_read_b64_tr_b16 v[88:89], v6 offset:20480
    ds_read_b64_tr_b16 v[90:91], v6 offset:21504
    ds_read_b64_tr_b16 v[92:93], v7 offset:20480
    ds_read_b64_tr_b16 v[94:95], v7 offset:21504
    v_mfma_f32_32x32x16_bf16 v[40:55], v[104:107], v[96:99], v[40:55]
    v_lshlrev_b32 v36, 16, v98
    v_and_b32 v37, 0xffff0000, v98
    v_add_f32 v32, v32, v36
    v_add_f32 v33, v33, v37
    v_fmac_f32 v34, v36, v36
    v_fmac_f32 v35, v37, v37
    v_mfma_f32_32x32x16_bf16 v[56:71], v[108:111], v[96:99], v[56:71]
    v_lshlrev_b32 v38, 16, v99
    v_and_b32 v39, 0xffff0000, v99
    v_add_f32 v32, v32, v38
    v_add_f32 v33, v33, v39
    v_fmac_f32 v34, v38, v38
    v_fmac_f32 v35, v39, v39
    v_mfma_f32_32x32x16_bf16 v[40:55], v[112:115], v[100:103], v[40:55]
    v_lshlrev_b32 v36, 16, v102
    v_and_b32 v37, 0xffff0000, v102
    v_add_f32 v32, v32, v36
    v_add_f32 v33, v33, v37
    v_fmac_f32 v34, v36, v36
    v_fmac_f32 v35, v37, v37
    v_mfma_f32_32x32x16_bf16 v[56:71], v[116:119], v[100:103], v[56:71]
    v_lshlrev_b32 v38, 16, v103
    v_and_b32 v39, 0xffff0000, v103
    v_add_f32 v32, v32, v38
    v_add_f32 v33, v33, v39
    v_fmac_f32 v34, v38, v38
    v_fmac_f32 v35, v39, v39
    s_cbranch_vccz L_qab_ns17
    v_mfma_f32_16x16x32_bf16 v[16:19], v[104:107], v[20:23], v[16:19]
    v_mfma_f32_16x16x32_bf16 v[16:19], v[112:115], v[20:23], v[16:19]
L_qab_ns17:
    s_waitcnt lgkmcnt(0)
    s_waitcnt vmcnt(0)
    s_barrier
    ds_read_b128 v[96:99], v14 offset:16384
    ds_read_b64_tr_b16 v[104:105], v6 offset:24576
    ds_read_b64_tr_b16 v[106:107], v6 offset:25600
    ds_read_b64_tr_b16 v[108:109], v7 offset:24576
    ds_read_b64_tr_b16 v[110:111], v7 offset:25600
    ds_read_b128 v[100:103], v15 offset:16384
    ds_read_b64_tr_b16 v[112:113], v6 offset:28672
    ds_read_b64_tr_b16 v[114:115], v6 offset:29696
    ds_read_b64_tr_b16 v[116:117], v7 offset:28672
    ds_read_b64_tr_b16 v[118:119], v7 offset:29696
    v_mfma_f32_32x32x16_bf16 v[40:55], v[80:83], v[72:75], v[40:55]
    v_lshlrev_b32 v36, 16, v74
    v_and_b32 v37, 0xffff0000, v74
    v_add_f32 v32, v32, v36
    v_add_f32 v33, v33, v37
    v_fmac_f32 v34, v36, v36
    v_fmac_f32 v35, v37, v37
    v_mfma_f32_32x32x16_bf16 v[56:71], v[84:87], v[72:75], v[56:71]
    v_lshlrev_b32 v38, 16, v75
    v_and_b32 v39, 0xffff0000, v75
    v_add_f32 v32, v32, v38
    v_add_f32 v33, v33, v39
    v_fmac_f32 v34, v38, v38
    v_fmac_f32 v35, v39, v39
    v_mfma_f32_32x32x16_bf16 v[40:55], v[88:91], v[76:79], v[40:55]
    v_lshlrev_b32 v36, 16, v78
    v_and_b32 v37, 0xffff0000, v78
    v_add_f32 v32, v32, v36
    v_add_f32 v33, v33, v37
    v_fmac_f32 v34, v36, v36
    v_fmac_f32 v35, v37, v37
    v_mfma_f32_32x32x16_bf16 v[56:71], v[92:95], v[76:79], v[56:71]
    v_lshlrev_b32 v38, 16, v79
    v_and_b32 v39, 0xffff0000, v79
    v_add_f32 v32, v32, v38
    v_add_f32 v33, v33, v39
    v_fmac_f32 v34, v38, v38
    v_fmac_f32 v35, v39, v39
    s_cbranch_vccz L_qab_ns18
    v_mfma_f32_16x16x32_bf16 v[16:19], v[80:83], v[20:23], v[16:19]
    v_mfma_f32_16x16x32_bf16 v[16:19], v[88:91], v[20:23], v[16:19]
L_qab_ns18:
    s_waitcnt lgkmcnt(0)
    v_mfma_f32_32x32x16_bf16 v[40:55], v[104:107], v[96:99], v[40:55]
    v_lshlrev_b32 v36, 16, v98
    v_and_b32 v37, 0xffff0000, v98
    v_add_f32 v32, v32, v36
    v_add_f32 v33, v33, v37
    v_fmac_f32 v34, v36, v36
    v_fmac_f32 v35, v37, v37
    v_mfma_f32_32x32x16_bf16 v[56:71], v[108:111], v[96:99], v[56:71]
    v_lshlrev_b32 v38, 16, v99
    v_and_b32 v39, 0xffff0000, v99
    v_add_f32 v32, v32, v38
    v_add_f32 v33, v33, v39
    v_fmac_f32 v34, v38, v38
    v_fmac_f32 v35, v39, v39
    v_mfma_f32_32x32x16_bf16 v[40:55], v[112:115], v[100:103], v[40:55]
    v_lshlrev_b32 v36, 16, v102
    v_and_b32 v37, 0xffff0000, v102
    v_add_f32 v32, v32, v36
    v_add_f32 v33, v33, v37
    v_fmac_f32 v34, v36, v36
    v_fmac_f32 v35, v37, v37
    v_mfma_f32_32x32x16_bf16 v[56:71], v[116:119], v[100:103], v[56:71]
    v_lshlrev_b32 v38, 16, v103
    v_and_b32 v39, 0xffff0000, v103
    v_add_f32 v32, v32, v38
    v_add_f32 v33, v33, v39
    v_fmac_f32 v34, v38, v38
    v_fmac_f32 v35, v39, v39
    s_cbranch_vccz L_qab_ns19
    v_mfma_f32_16x16x32_bf16 v[16:19], v[104:107], v[20:23], v[16:19]
    v_mfma_f32_16x16x32_bf16 v[16:19], v[112:115], v[20:23], v[16:19]
L_qab_ns19:
    s_branch L_qa_post
L_qa_cform:
    s_cmp_eq_u32 s25, 0
    s_cbranch_scc0 L_qa_c1
    s_mov_b32 s48, 0
    s_mov_b32 s34, 0
    s_add_u32 m0, s49, 0
    s_nop 0
    buffer_load_dwordx4 v5, s[8:11], s48 offen lds
    s_add_u32 m0, s49, 1024
    s_nop 0
    buffer_load_dwordx4 v11, s[8:11], s48 offen lds
    s_add_u32 s48, s48, 128
    s_add_u32 m0, s28, 32768
    s_nop 0
    buffer_load_dwordx4 v4, s[12:15], s34 offen lds
    s_add_u32 s34, s34, s33
    s_add_u32 m0, s28, 40960
    s_nop 0
    buffer_load_dwordx4 v4, s[12:15], s34 offen lds
    s_add_u32 s34, s34, s33
    s_add_u32 m0, s49, 16384
    s_nop 0
    buffer_load_dwordx4 v5, s[8:11], s48 offen lds
    s_add_u32 m0, s49, 17408
    s_nop 0
    buffer_load_dwordx4 v11, s[8:11], s48 offen lds
    s_add_u32 s48, s48, 128
    s_add_u32 m0, s28, 49152
    s_nop 0
    buffer_load_dwordx4 v4, s[12:15], s34 offen lds
    s_add_u32 s34, s34, s33
    s_add_u32 m0, s28, 57344
    s_nop 0
    buffer_load_dwordx4 v4, s[12:15], s34 offen lds
    s_add_u32 s34, s34, s33
    s_lshl_b32 s37, s24, 5
    v_add_u32 v24, s37, v3
    v_bfe_u32 v25, v24, 2, 2
    v_lshlrev_b32 v24, 6, v24
    v_add_u32 v26, 0, v1
    v_xor_b32 v26, v26, v25
    v_lshl_add_u32 v8, v26, 4, v24
    v_add_u32 v26, 2, v1
    v_xor_b32 v26, v26, v25
    v_lshl_add_u32 v9, v26, 4, v24
    v_bfe_u32 v24, v2, 2, 2
    v_lshl_add_u32 v27, v1, 3, v24
    v_mul_u32_u24 v27, 256, v27
    v_and_b32 v25, 3, v2
    v_lshl_add_u32 v27, v25, 3, v27
    v_bfe_u32 v25, v2, 4, 1
    v_lshl_add_u32 v27, v25, 5, v27
    v_xor_b32 v26, s40, v24
    v_lshl_add_u32 v6, v26, 6, v27
    v_add_u32 v6, 32768, v6
    v_xor_b32 v26, s41, v24
    v_lshl_add_u32 v7, v26, 6, v27
    v_add_u32 v7, 32768, v7
    s_lshl_b32 s37, s24, 5
    v_add_u32 v24, s37, v3
    v_bfe_u32 v25, v24, 1, 3
    v_lshlrev_b32 v24, 7, v24
    v_add_u32 v26, 0, v1
    v_xor_b32 v26, v26, v25
    v_lshl_add_u32 v8, v26, 4, v24
    v_add_u32 v26, 2, v1
    v_xor_b32 v26, v26, v25
    v_lshl_add_u32 v9, v26, 4, v24
    v_add_u32 v26, 4, v1
    v_xor_b32 v26, v26, v25
    v_lshl_add_u32 v14, v26, 4, v24
    v_add_u32 v26, 6, v1
    v_xor_b32 v26, v26, v25
    v_lshl_add_u32 v15, v26, 4, v24
    v_and_b32 v24, 15, v2
    v_lshrrev_b32 v25, 4, v2
    v_cmp_eq_u32 vcc, v24, v25
    v_mov_b32 v26, 0x3f803f80
    s_nop 0
    v_cndmask_b32 v20, 0, v26, vcc
    v_cndmask_b32 v21, 0, v26, vcc
    v_cndmask_b32 v22, 0, v26, vcc
    v_cndmask_b32 v23, 0, v26, vcc
    v_mov_b32 v32, 0
    v_mov_b32 v33, 0
    v_mov_b32 v34, 0
    v_mov_b32 v35, 0
    v_mov_b32 v16, 0
    v_mov_b32 v17, 0
    v_mov_b32 v18, 0
    v_mov_b32 v19, 0
    v_mov_b32 v40, 0
    v_mov_b32 v41, 0
    v_mov_b32 v42, 0
    v_mov_b32 v43, 0
    v_mov_b32 v44, 0
    v_mov_b32 v45, 0
    v_mov_b32 v46, 0
    v_mov_b32 v47, 0
    v_mov_b32 v48, 0
    v_mov_b32 v49, 0
    v_mov_b32 v50, 0
    v_mov_b32 v51, 0
    v_mov_b32 v52, 0
    v_mov_b32 v53, 0
    v_mov_b32 v54, 0
    v_mov_b32 v55, 0
    v_mov_b32 v56, 0
    v_mov_b32 v57, 0
    v_mov_b32 v58, 0
    v_mov_b32 v59, 0
    v_mov_b32 v60, 0
    v_mov_b32 v61, 0
    v_mov_b32 v62, 0
    v_mov_b32 v63, 0
    v_mov_b32 v64, 0
    v_mov_b32 v65, 0
    v_mov_b32 v66, 0
    v_mov_b32 v67, 0
    v_mov_b32 v68, 0
    v_mov_b32 v69, 0
    v_mov_b32 v70, 0
    v_mov_b32 v71, 0
    s_cmp_lt_u32 s24, 2
    s_cselect_b64 vcc, -1, 0
    s_mov_b32 s42, 0
    s_waitcnt vmcnt(5)
    s_barrier
    ds_read_b128 v[72:75], v8 offset:0
    ds_read_b64_tr_b16 v[80:81], v6 offset:0
    ds_read_b64_tr_b16 v[82:83], v6 offset:1024
    ds_read_b64_tr_b16 v[84:85], v7 offset:0
    ds_read_b64_tr_b16 v[86:87], v7 offset:1024
    ds_read_b128 v[76:79], v9 offset:0
    ds_read_b64_tr_b16 v[88:89], v6 offset:4096
    ds_read_b64_tr_b16 v[90:91], v6 offset:5120
    ds_read_b64_tr_b16 v[92:93], v7 offset:4096
    ds_read_b64_tr_b16 v[94:95], v7 offset:5120
L_qac_loop:
    s_waitcnt lgkmcnt(0)
    s_waitcnt vmcnt(4)
    s_barrier
    ds_read_b128 v[96:99], v14 offset:0
    ds_read_b64_tr_b16 v[104:105], v6 offset:8192
    ds_read_b64_tr_b16 v[106:107], v6 offset:9216
    ds_read_b64_tr_b16 v[108:109], v7 offset:8192
    ds_read_b64_tr_b16 v[110:111], v7 offset:9216
    ds_read_b128 v[100:103], v15 offset:0
    ds_read_b64_tr_b16 v[112:113], v6 offset:12288
    ds_read_b64_tr_b16 v[114:115], v6 offset:13312
    ds_read_b64_tr_b16 v[116:117], v7 offset:12288
    ds_read_b64_tr_b16 v[118:119], v7 offset:13312
    v_mfma_f32_32x32x16_bf16 v[40:55], v[72:75], v[80:83], v[40:55]
    s_add_u32 m0, s28, 32768
    s_nop 0
    buffer_load_dwordx4 v4, s[12:15], s34 offen lds
    s_add_u32 s34, s34, s33
    v_lshlrev_b32 v36, 16, v72
    v_and_b32 v37, 0xffff0000, v72
    v_add_f32 v32, v32, v36
    v_add_f32 v33, v33, v37
    v_fmac_f32 v34, v36, v36
    v_fmac_f32 v35, v37, v37
    v_mfma_f32_32x32x16_bf16 v[56:71], v[72:75], v[84:87], v[56:71]
    v_lshlrev_b32 v38, 16, v73
    v_and_b32 v39, 0xffff0000, v73
    v_add_f32 v32, v32, v38
    v_add_f32 v33, v33, v39
    v_fmac_f32 v34, v38, v38
    v_fmac_f32 v35, v39, v39
    v_mfma_f32_32x32x16_bf16 v[40:55], v[76:79], v[88:91], v[40:55]
    v_lshlrev_b32 v36, 16, v76
    v_and_b32 v37, 0xffff0000, v76
    v_add_f32 v32, v32, v36
    v_add_f32 v33, v33, v37
    v_fmac_f32 v34, v36, v36
    v_fmac_f32 v35, v37, v37
    v_mfma_f32_32x32x16_bf16 v[56:71], v[76:79], v[92:95], v[56:71]
    v_lshlrev_b32 v38, 16, v77
    v_and_b32 v39, 0xffff0000, v77
    v_add_f32 v32, v32, v38
    v_add_f32 v33, v33, v39
    v_fmac_f32 v34, v38, v38
    v_fmac_f32 v35, v39, v39
    s_cbranch_vccz L_qac_ns0
    v_mfma_f32_16x16x32_bf16 v[16:19], v[80:83], v[20:23], v[16:19]
    v_mfma_f32_16x16x32_bf16 v[16:19], v[88:91], v[20:23], v[16:19]
L_qac_ns0:
    s_waitcnt lgkmcnt(0)
    s_waitcnt vmcnt(1)
    s_barrier
    ds_read_b128 v[72:75], v8 offset:16384
    ds_read_b64_tr_b16 v[80:81], v6 offset:16384
    ds_read_b64_tr_b16 v[82:83], v6 offset:17408
    ds_read_b64_tr_b16 v[84:85], v7 offset:16384
    ds_read_b64_tr_b16 v[86:87], v7 offset:17408
    ds_read_b128 v[76:79], v9 offset:16384
    ds_read_b64_tr_b16 v[88:89], v6 offset:20480
    ds_read_b64_tr_b16 v[90:91], v6 offset:21504
    ds_read_b64_tr_b16 v[92:93], v7 offset:20480
    ds_read_b64_tr_b16 v[94:95], v7 offset:21504
    v_mfma_f32_32x32x16_bf16 v[40:55], v[96:99], v[104:107], v[40:55]
    s_add_u32 m0, s49, 0
    s_nop 0
    buffer_load_dwordx4 v5, s[8:11], s48 offen lds
    v_lshlrev_b32 v36, 16, v96
    v_and_b32 v37, 0xffff0000, v96
    v_add_f32 v32, v32, v36
    v_add_f32 v33, v33, v37
    v_fmac_f32 v34, v36, v36
    v_fmac_f32 v35, v37, v37
    v_mfma_f32_32x32x16_bf16 v[56:71], v[96:99], v[108:111], v[56:71]
    s_add_u32 m0, s49, 1024
    s_nop 0
    buffer_load_dwordx4 v11, s[8:11], s48 offen lds
    s_add_u32 s48, s48, 128
    v_lshlrev_b32 v38, 16, v97
    v_and_b32 v39, 0xffff0000, v97
    v_add_f32 v32, v32, v38
    v_add_f32 v33, v33, v39
    v_fmac_f32 v34, v38, v38
    v_fmac_f32 v35, v39, v39
    v_mfma_f32_32x32x16_bf16 v[40:55], v[100:103], v[112:115], v[40:55]
    s_add_u32 m0, s28, 40960
    s_nop 0
    buffer_load_dwordx4 v4, s[12:15], s34 offen lds
    s_add_u32 s34, s34, s33
    v_lshlrev_b32 v36, 16, v100
    v_and_b32 v37, 0xffff0000, v100
    v_add_f32 v32, v32, v36
    v_add_f32 v33, v33, v37
    v_fmac_f32 v34, v36, v36
    v_fmac_f32 v35, v37, v37
    v_mfma_f32_32x32x16_bf16 v[56:71], v[100:103], v[116:119], v[56:71]
    v_lshlrev_b32 v38, 16, v101
    v_and_b32 v39, 0xffff0000, v101
    v_add_f32 v32, v32, v38
    v_add_f32 v33, v33, v39
    v_fmac_f32 v34, v38, v38
    v_fmac_f32 v35, v39, v39
    s_cbranch_vccz L_qac_ns1
    v_mfma_f32_16x16x32_bf16 v[16:19], v[104:107], v[20:23], v[16:19]
    v_mfma_f32_16x16x32_bf16 v[16:19], v[112:115], v[20:23], v[16:19]
L_qac_ns1:
    s_waitcnt lgkmcnt(0)
    s_waitcnt vmcnt(4)
    s_barrier
    ds_read_b128 v[96:99], v14 offset:16384
    ds_read_b64_tr_b16 v[104:105], v6 offset:24576
    ds_read_b64_tr_b16 v[106:107], v6 offset:25600
    ds_read_b64_tr_b16 v[108:109], v7 offset:24576
    ds_read_b64_tr_b16 v[110:111], v7 offset:25600
    ds_read_b128 v[100:103], v15 offset:16384
    ds_read_b64_tr_b16 v[112:113], v6 offset:28672
    ds_read_b64_tr_b16 v[114:115], v6 offset:29696
    ds_read_b64_tr_b16 v[116:117], v7 offset:28672
    ds_read_b64_tr_b16 v[118:119], v7 offset:29696
    v_mfma_f32_32x32x16_bf16 v[40:55], v[72:75], v[80:83], v[40:55]
    s_add_u32 m0, s28, 49152
    s_nop 0
    buffer_load_dwordx4 v4, s[12:15], s34 offen lds
    s_add_u32 s34, s34, s33
    v_lshlrev_b32 v36, 16, v72
    v_and_b32 v37, 0xffff0000, v72
    v_add_f32 v32, v32, v36
    v_add_f32 v33, v33, v37
    v_fmac_f32 v34, v36, v36
    v_fmac_f32 v35, v37, v37
    v_mfma_f32_32x32x16_bf16 v[56:71], v[72:75], v[84:87], v[56:71]
    v_lshlrev_b32 v38, 16, v73
    v_and_b32 v39, 0xffff0000, v73
    v_add_f32 v32, v32, v38
    v_add_f32 v33, v33, v39
    v_fmac_f32 v34, v38, v38
    v_fmac_f32 v35, v39, v39
    v_mfma_f32_32x32x16_bf16 v[40:55], v[76:79], v[88:91], v[40:55]
    v_lshlrev_b32 v36, 16, v76
    v_and_b32 v37, 0xffff0000, v76
    v_add_f32 v32, v32, v36
    v_add_f32 v33, v33, v37
    v_fmac_f32 v34, v36, v36
    v_fmac_f32 v35, v37, v37
    v_mfma_f32_32x32x16_bf16 v[56:71], v[76:79], v[92:95], v[56:71]
    v_lshlrev_b32 v38, 16, v77
    v_and_b32 v39, 0xffff0000, v77
    v_add_f32 v32, v32, v38
    v_add_f32 v33, v33, v39
    v_fmac_f32 v34, v38, v38
    v_fmac_f32 v35, v39, v39
    s_cbranch_vccz L_qac_ns2
    v_mfma_f32_16x16x32_bf16 v[16:19], v[80:83], v[20:23], v[16:19]
    v_mfma_f32_16x16x32_bf16 v[16:19], v[88:91], v[20:23], v[16:19]
L_qac_ns2:
    s_waitcnt lgkmcnt(0)
    s_waitcnt vmcnt(1)
    s_barrier
    ds_read_b128 v[72:75], v8 offset:0
    ds_read_b64_tr_b16 v[80:81], v6 offset:0
    ds_read_b64_tr_b16 v[82:83], v6 offset:1024
    ds_read_b64_tr_b16 v[84:85], v7 offset:0
    ds_read_b64_tr_b16 v[86:87], v7 offset:1024
    ds_read_b128 v[76:79], v9 offset:0
    ds_read_b64_tr_b16 v[88:89], v6 offset:4096
    ds_read_b64_tr_b16 v[90:91], v6 offset:5120
    ds_read_b64_tr_b16 v[92:93], v7 offset:4096
    ds_read_b64_tr_b16 v[94:95], v7 offset:5120
    v_mfma_f32_32x32x16_bf16 v[40:55], v[96:99], v[104:107], v[40:55]
    s_add_u32 m0, s49, 16384
    s_nop 0
    buffer_load_dwordx4 v5, s[8:11], s48 offen lds
    v_lshlrev_b32 v36, 16, v96
    v_and_b32 v37, 0xffff0000, v96
    v_add_f32 v32, v32, v36
    v_add_f32 v33, v33, v37
    v_fmac_f32 v34, v36, v36
    v_fmac_f32 v35, v37, v37
    v_mfma_f32_32x32x16_bf16 v[56:71], v[96:99], v[108:111], v[56:71]
    s_add_u32 m0, s49, 17408
    s_nop 0
    buffer_load_dwordx4 v11, s[8:11], s48 offen lds
    s_add_u32 s48, s48, 128
    v_lshlrev_b32 v38, 16, v97
    v_and_b32 v39, 0xffff0000, v97
    v_add_f32 v32, v32, v38
    v_add_f32 v33, v33, v39
    v_fmac_f32 v34, v38, v38
    v_fmac_f32 v35, v39, v39
    v_mfma_f32_32x32x16_bf16 v[40:55], v[100:103], v[112:115], v[40:55]
    s_add_u32 m0, s28, 57344
    s_nop 0
    buffer_load_dwordx4 v4, s[12:15], s34 offen lds
    s_add_u32 s34, s34, s33
    v_lshlrev_b32 v36, 16, v100
    v_and_b32 v37, 0xffff0000, v100
    v_add_f32 v32, v32, v36
    v_add_f32 v33, v33, v37
    v_fmac_f32 v34, v36, v36
    v_fmac_f32 v35, v37, v37
    v_mfma_f32_32x32x16_bf16 v[56:71], v[100:103], v[116:119], v[56:71]
    v_lshlrev_b32 v38, 16, v101
    v_and_b32 v39, 0xffff0000, v101
    v_add_f32 v32, v32, v38
    v_add_f32 v33, v33, v39
    v_fmac_f32 v34, v38, v38
    v_fmac_f32 v35, v39, v39
    s_cbranch_vccz L_qac_ns3
    v_mfma_f32_16x16x32_bf16 v[16:19], v[104:107], v[20:23], v[16:19]
    v_mfma_f32_16x16x32_bf16 v[16:19], v[112:115], v[20:23], v[16:19]
L_qac_ns3:
    s_add_u32 s42, s42, 1
    s_cmp_lt_u32 s42, 4
    s_cbranch_scc1 L_qac_loop
    s_waitcnt lgkmcnt(0)
    s_waitcnt vmcnt(3)
    s_barrier
    ds_read_b128 v[96:99], v14 offset:0
    ds_read_b64_tr_b16 v[104:105], v6 offset:8192
    ds_read_b64_tr_b16 v[106:107], v6 offset:9216
    ds_read_b64_tr_b16 v[108:109], v7 offset:8192
    ds_read_b64_tr_b16 v[110:111], v7 offset:9216
    ds_read_b128 v[100:103], v15 offset:0
    ds_read_b64_tr_b16 v[112:113], v6 offset:12288
    ds_read_b64_tr_b16 v[114:115], v6 offset:13312
    ds_read_b64_tr_b16 v[116:117], v7 offset:12288
    ds_read_b64_tr_b16 v[118:119], v7 offset:13312
    v_mfma_f32_32x32x16_bf16 v[40:55], v[72:75], v[80:83], v[40:55]
    v_lshlrev_b32 v36, 16, v72
    v_and_b32 v37, 0xffff0000, v72
    v_add_f32 v32, v32, v36
    v_add_f32 v33, v33, v37
    v_fmac_f32 v34, v36, v36
    v_fmac_f32 v35, v37, v37
    v_mfma_f32_32x32x16_bf16 v[56:71], v[72:75], v[84:87], v[56:71]
    v_lshlrev_b32 v38, 16, v73
    v_and_b32 v39, 0xffff0000, v73
    v_add_f32 v32, v32, v38
    v_add_f32 v33, v33, v39
    v_fmac_f32 v34, v38, v38
    v_fmac_f32 v35, v39, v39
    v_mfma_f32_32x32x16_bf16 v[40:55], v[76:79], v[88:91], v[40:55]
    v_lshlrev_b32 v36, 16, v76
    v_and_b32 v37, 0xffff0000, v76
    v_add_f32 v32, v32, v36
    v_add_f32 v33, v33, v37
    v_fmac_f32 v34, v36, v36
    v_fmac_f32 v35, v37, v37
    v_mfma_f32_32x32x16_bf16 v[56:71], v[76:79], v[92:95], v[56:71]
    v_lshlrev_b32 v38, 16, v77
    v_and_b32 v39, 0xffff0000, v77
    v_add_f32 v32, v32, v38
    v_add_f32 v33, v33, v39
    v_fmac_f32 v34, v38, v38
    v_fmac_f32 v35, v39, v39
    s_cbranch_vccz L_qac_ns16
    v_mfma_f32_16x16x32_bf16 v[16:19], v[80:83], v[20:23], v[16:19]
    v_mfma_f32_16x16x32_bf16 v[16:19], v[88:91], v[20:23], v[16:19]
L_qac_ns16:
    s_waitcnt lgkmcnt(0)
    s_waitcnt vmcnt(0)
    s_barrier
    ds_read_b128 v[72:75], v8 offset:16384
    ds_read_b64_tr_b16 v[80:81], v6 offset:16384
    ds_read_b64_tr_b16 v[82:83], v6 offset:17408
    ds_read_b64_tr_b16 v[84:85], v7 offset:16384
    ds_read_b64_tr_b16 v[86:87], v7 offset:17408
    ds_read_b128 v[76:79], v9 offset:16384
    ds_read_b64_tr_b16 v[88:89], v6 offset:20480
    ds_read_b64_tr_b16 v[90:91], v6 offset:21504
    ds_read_b64_tr_b16 v[92:93], v7 offset:20480
    ds_read_b64_tr_b16 v[94:95], v7 offset:21504
    v_mfma_f32_32x32x16_bf16 v[40:55], v[96:99], v[104:107], v[40:55]
    v_lshlrev_b32 v36, 16, v96
    v_and_b32 v37, 0xffff0000, v96
    v_add_f32 v32, v32, v36
    v_add_f32 v33, v33, v37
    v_fmac_f32 v34, v36, v36
    v_fmac_f32 v35, v37, v37
    v_mfma_f32_32x32x16_bf16 v[56:71], v[96:99], v[108:111], v[56:71]
    v_lshlrev_b32 v38, 16, v97
    v_and_b32 v39, 0xffff0000, v97
    v_add_f32 v32, v32, v38
    v_add_f32 v33, v33, v39
    v_fmac_f32 v34, v38, v38
    v_fmac_f32 v35, v39, v39
    v_mfma_f32_32x32x16_bf16 v[40:55], v[100:103], v[112:115], v[40:55]
    v_lshlrev_b32 v36, 16, v100
    v_and_b32 v37, 0xffff0000, v100
    v_add_f32 v32, v32, v36
    v_add_f32 v33, v33, v37
    v_fmac_f32 v34, v36, v36
    v_fmac_f32 v35, v37, v37
    v_mfma_f32_32x32x16_bf16 v[56:71], v[100:103], v[116:119], v[56:71]
    v_lshlrev_b32 v38, 16, v101
    v_and_b32 v39, 0xffff0000, v101
    v_add_f32 v32, v32, v38
    v_add_f32 v33, v33, v39
    v_fmac_f32 v34, v38, v38
    v_fmac_f32 v35, v39, v39
    s_cbranch_vccz L_qac_ns17
    v_mfma_f32_16x16x32_bf16 v[16:19], v[104:107], v[20:23], v[16:19]
    v_mfma_f32_16x16x32_bf16 v[16:19], v[112:115], v[20:23], v[16:19]
L_qac_ns17:
    s_waitcnt lgkmcnt(0)
    s_waitcnt vmcnt(0)
    s_barrier
    ds_read_b128 v[96:99], v14 offset:16384
    ds_read_b64_tr_b16 v[104:105], v6 offset:24576
    ds_read_b64_tr_b16 v[106:107], v6 offset:25600
    ds_read_b64_tr_b16 v[108:109], v7 offset:24576
    ds_read_b64_tr_b16 v[110:111], v7 offset:25600
    ds_read_b128 v[100:103], v15 offset:16384
    ds_read_b64_tr_b16 v[112:113], v6 offset:28672
    ds_read_b64_tr_b16 v[114:115], v6 offset:29696
    ds_read_b64_tr_b16 v[116:117], v7 offset:28672
    ds_read_b64_tr_b16 v[118:119], v7 offset:29696
    v_mfma_f32_32x32x16_bf16 v[40:55], v[72:75], v[80:83], v[40:55]
    v_lshlrev_b32 v36, 16, v72
    v_and_b32 v37, 0xffff0000, v72
    v_add_f32 v32, v32, v36
    v_add_f32 v33, v33, v37
    v_fmac_f32 v34, v36, v36
    v_fmac_f32 v35, v37, v37
    v_mfma_f32_32x32x16_bf16 v[56:71], v[72:75], v[84:87], v[56:71]
    v_lshlrev_b32 v38, 16, v73
    v_and_b32 v39, 0xffff0000, v73
    v_add_f32 v32, v32, v38
    v_add_f32 v33, v33, v39
    v_fmac_f32 v34, v38, v38
    v_fmac_f32 v35, v39, v39
    v_mfma_f32_32x32x16_bf16 v[40:55], v[76:79], v[88:91], v[40:55]
    v_lshlrev_b32 v36, 16, v76
    v_and_b32 v37, 0xffff0000, v76
    v_add_f32 v32, v32, v36
    v_add_f32 v33, v33, v37
    v_fmac_f32 v34, v36, v36
    v_fmac_f32 v35, v37, v37
    v_mfma_f32_32x32x16_bf16 v[56:71], v[76:79], v[92:95], v[56:71]
    v_lshlrev_b32 v38, 16, v77
    v_and_b32 v39, 0xffff0000, v77
    v_add_f32 v32, v32, v38
    v_add_f32 v33, v33, v39
    v_fmac_f32 v34, v38, v38
    v_fmac_f32 v35, v39, v39
    s_cbranch_vccz L_qac_ns18
    v_mfma_f32_16x16x32_bf16 v[16:19], v[80:83], v[20:23], v[16:19]
    v_mfma_f32_16x16x32_bf16 v[16:19], v[88:91], v[20:23], v[16:19]
L_qac_ns18:
    s_waitcnt lgkmcnt(0)
    v_mfma_f32_32x32x16_bf16 v[40:55], v[96:99], v[104:107], v[40:55]
    v_lshlrev_b32 v36, 16, v96
    v_and_b32 v37, 0xffff0000, v96
    v_add_f32 v32, v32, v36
    v_add_f32 v33, v33, v37
    v_fmac_f32 v34, v36, v36
    v_fmac_f32 v35, v37, v37
    v_mfma_f32_32x32x16_bf16 v[56:71], v[96:99], v[108:111], v[56:71]
    v_lshlrev_b32 v38, 16, v97
    v_and_b32 v39, 0xffff0000, v97
    v_add_f32 v32, v32, v38
    v_add_f32 v33, v33, v39
    v_fmac_f32 v34, v38, v38
    v_fmac_f32 v35, v39, v39
    v_mfma_f32_32x32x16_bf16 v[40:55], v[100:103], v[112:115], v[40:55]
    v_lshlrev_b32 v36, 16, v100
    v_and_b32 v37, 0xffff0000, v100
    v_add_f32 v32, v32, v36
    v_add_f32 v33, v33, v37
    v_fmac_f32 v34, v36, v36
    v_fmac_f32 v35, v37, v37
    v_mfma_f32_32x32x16_bf16 v[56:71], v[100:103], v[116:119], v[56:71]
    v_lshlrev_b32 v38, 16, v101
    v_and_b32 v39, 0xffff0000, v101
    v_add_f32 v32, v32, v38
    v_add_f32 v33, v33, v39
    v_fmac_f32 v34, v38, v38
    v_fmac_f32 v35, v39, v39
    s_cbranch_vccz L_qac_ns19
    v_mfma_f32_16x16x32_bf16 v[16:19], v[104:107], v[20:23], v[16:19]
    v_mfma_f32_16x16x32_bf16 v[16:19], v[112:115], v[20:23], v[16:19]
L_qac_ns19:
    s_branch L_qa_post
L_qa_c1:
    s_mov_b32 s48, 0
    s_mov_b32 s34, 0
    s_add_u32 m0, s49, 0
    s_nop 0
    buffer_load_dwordx4 v5, s[8:11], s48 offen lds
    s_add_u32 m0, s49, 1024
    s_nop 0
    buffer_load_dwordx4 v11, s[8:11], s48 offen lds
    s_add_u32 s48, s48, 128
    s_add_u32 m0, s28, 32768
    s_nop 0
    buffer_load_dwordx4 v4, s[12:15], s34 offen lds
    s_add_u32 s34, s34, s33
    s_add_u32 m0, s28, 40960
    s_nop 0
    buffer_load_dwordx4 v4, s[12:15], s34 offen lds
    s_add_u32 s34, s34, s33
    s_add_u32 m0, s49, 16384
    s_nop 0
    buffer_load_dwordx4 v5, s[8:11], s48 offen lds
    s_add_u32 m0, s49, 17408
    s_nop 0
    buffer_load_dwordx4 v11, s[8:11], s48 offen lds
    s_add_u32 s48, s48, 128
    s_add_u32 m0, s28, 49152
    s_nop 0
    buffer_load_dwordx4 v4, s[12:15], s34 offen lds
    s_add_u32 s34, s34, s33
    s_add_u32 m0, s28, 57344
    s_nop 0
    buffer_load_dwordx4 v4, s[12:15], s34 offen lds
    s_add_u32 s34, s34, s33
    s_lshl_b32 s37, s24, 5
    v_add_u32 v24, s37, v3
    v_bfe_u32 v25, v24, 2, 2
    v_lshlrev_b32 v24, 6, v24
    v_add_u32 v26, 0, v1
    v_xor_b32 v26, v26, v25
    v_lshl_add_u32 v8, v26, 4, v24
    v_add_u32 v26, 2, v1
    v_xor_b32 v26, v26, v25
    v_lshl_add_u32 v9, v26, 4, v24
    v_bfe_u32 v24, v2, 2, 2
    v_lshl_add_u32 v27, v1, 3, v24
    v_mul_u32_u24 v27, 256, v27
    v_and_b32 v25, 3, v2
    v_lshl_add_u32 v27, v25, 3, v27
    v_bfe_u32 v25, v2, 4, 1
    v_lshl_add_u32 v27, v25, 5, v27
    v_xor_b32 v26, s40, v24
    v_lshl_add_u32 v6, v26, 6, v27
    v_add_u32 v6, 32768, v6
    v_xor_b32 v26, s41, v24
    v_lshl_add_u32 v7, v26, 6, v27
    v_add_u32 v7, 32768, v7
    s_lshl_b32 s37, s24, 5
    v_add_u32 v24, s37, v3
    v_bfe_u32 v25, v24, 1, 3
    v_lshlrev_b32 v24, 7, v24
    v_add_u32 v26, 0, v1
    v_xor_b32 v26, v26, v25
    v_lshl_add_u32 v8, v26, 4, v24
    v_add_u32 v26, 2, v1
    v_xor_b32 v26, v26, v25
    v_lshl_add_u32 v9, v26, 4, v24
    v_add_u32 v26, 4, v1
    v_xor_b32 v26, v26, v25
    v_lshl_add_u32 v14, v26, 4, v24
    v_add_u32 v26, 6, v1
    v_xor_b32 v26, v26, v25
    v_lshl_add_u32 v15, v26, 4, v24
    v_and_b32 v24, 15, v2
    v_lshrrev_b32 v25, 4, v2
    v_cmp_eq_u32 vcc, v24, v25
    v_mov_b32 v26, 0x3f803f80
    s_nop 0
    v_cndmask_b32 v20, 0, v26, vcc
    v_cndmask_b32 v21, 0, v26, vcc
    v_cndmask_b32 v22, 0, v26, vcc
    v_cndmask_b32 v23, 0, v26, vcc
    v_mov_b32 v32, 0
    v_mov_b32 v33, 0
    v_mov_b32 v34, 0
    v_mov_b32 v35, 0
    v_mov_b32 v16, 0
    v_mov_b32 v17, 0
    v_mov_b32 v18, 0
    v_mov_b32 v19, 0
    v_mov_b32 v40, 0
    v_mov_b32 v41, 0
    v_mov_b32 v42, 0
    v_mov_b32 v43, 0
    v_mov_b32 v44, 0
    v_mov_b32 v45, 0
    v_mov_b32 v46, 0
    v_mov_b32 v47, 0
    v_mov_b32 v48, 0
    v_mov_b32 v49, 0
    v_mov_b32 v50, 0
    v_mov_b32 v51, 0
    v_mov_b32 v52, 0
    v_mov_b32 v53, 0
    v_mov_b32 v54, 0
    v_mov_b32 v55, 0
    v_mov_b32 v56, 0
    v_mov_b32 v57, 0
    v_mov_b32 v58, 0
    v_mov_b32 v59, 0
    v_mov_b32 v60, 0
    v_mov_b32 v61, 0
    v_mov_b32 v62, 0
    v_mov_b32 v63, 0
    v_mov_b32 v64, 0
    v_mov_b32 v65, 0
    v_mov_b32 v66, 0
    v_mov_b32 v67, 0
    v_mov_b32 v68, 0
    v_mov_b32 v69, 0
    v_mov_b32 v70, 0
    v_mov_b32 v71, 0
    s_cmp_lt_u32 s24, 2
    s_cselect_b64 vcc, -1, 0
    s_mov_b32 s42, 0
    s_waitcnt vmcnt(5)
    s_barrier
    ds_read_b128 v[72:75], v8 offset:0
    ds_read_b64_tr_b16 v[80:81], v6 offset:0
    ds_read_b64_tr_b16 v[82:83], v6 offset:1024
    ds_read_b64_tr_b16 v[84:85], v7 offset:0
    ds_read_b64_tr_b16 v[86:87], v7 offset:1024
    ds_read_b128 v[76:79], v9 offset:0
    ds_read_b64_tr_b16 v[88:89], v6 offset:4096
    ds_read_b64_tr_b16 v[90:91], v6 offset:5120
    ds_read_b64_tr_b16 v[92:93], v7 offset:4096
    ds_read_b64_tr_b16 v[94:95], v7 offset:5120
L_qad_loop:
    s_waitcnt lgkmcnt(0)
    s_waitcnt vmcnt(4)
    s_barrier
    ds_read_b128 v[96:99], v14 offset:0
    ds_read_b64_tr_b16 v[104:105], v6 offset:8192
    ds_read_b64_tr_b16 v[106:107], v6 offset:9216
    ds_read_b64_tr_b16 v[108:109], v7 offset:8192
    ds_read_b64_tr_b16 v[110:111], v7 offset:9216
    ds_read_b128 v[100:103], v15 offset:0
    ds_read_b64_tr_b16 v[112:113], v6 offset:12288
    ds_read_b64_tr_b16 v[114:115], v6 offset:13312
    ds_read_b64_tr_b16 v[116:117], v7 offset:12288
    ds_read_b64_tr_b16 v[118:119], v7 offset:13312
    v_mfma_f32_32x32x16_bf16 v[40:55], v[72:75], v[80:83], v[40:55]
    s_add_u32 m0, s28, 32768
    s_nop 0
    buffer_load_dwordx4 v4, s[12:15], s34 offen lds
    s_add_u32 s34, s34, s33
    v_lshlrev_b32 v36, 16, v74
    v_and_b32 v37, 0xffff0000, v74
    v_add_f32 v32, v32, v36
    v_add_f32 v33, v33, v37
    v_fmac_f32 v34, v36, v36
    v_fmac_f32 v35, v37, v37
    v_mfma_f32_32x32x16_bf16 v[56:71], v[72:75], v[84:87], v[56:71]
    v_lshlrev_b32 v38, 16, v75
    v_and_b32 v39, 0xffff0000, v75
    v_add_f32 v32, v32, v38
    v_add_f32 v33, v33, v39
    v_fmac_f32 v34, v38, v38
    v_fmac_f32 v35, v39, v39
    v_mfma_f32_32x32x16_bf16 v[40:55], v[76:79], v[88:91], v[40:55]
    v_lshlrev_b32 v36, 16, v78
    v_and_b32 v37, 0xffff0000, v78
    v_add_f32 v32, v32, v36
    v_add_f32 v33, v33, v37
    v_fmac_f32 v34, v36, v36
    v_fmac_f32 v35, v37, v37
    v_mfma_f32_32x32x16_bf16 v[56:71], v[76:79], v[92:95], v[56:71]
    v_lshlrev_b32 v38, 16, v79
    v_and_b32 v39, 0xffff0000, v79
    v_add_f32 v32, v32, v38
    v_add_f32 v33, v33, v39
    v_fmac_f32 v34, v38, v38
    v_fmac_f32 v35, v39, v39
    s_cbranch_vccz L_qad_ns0
    v_mfma_f32_16x16x32_bf16 v[16:19], v[80:83], v[20:23], v[16:19]
    v_mfma_f32_16x16x32_bf16 v[16:19], v[88:91], v[20:23], v[16:19]
L_qad_ns0:
    s_waitcnt lgkmcnt(0)
    s_waitcnt vmcnt(1)
    s_barrier
    ds_read_b128 v[72:75], v8 offset:16384
    ds_read_b64_tr_b16 v[80:81], v6 offset:16384
    ds_read_b64_tr_b16 v[82:83], v6 offset:17408
    ds_read_b64_tr_b16 v[84:85], v7 offset:16384
    ds_read_b64_tr_b16 v[86:87], v7 offset:17408
    ds_read_b128 v[76:79], v9 offset:16384
    ds_read_b64_tr_b16 v[88:89], v6 offset:20480
    ds_read_b64_tr_b16 v[90:91], v6 offset:21504
    ds_read_b64_tr_b16 v[92:93], v7 offset:20480
    ds_read_b64_tr_b16 v[94:95], v7 offset:21504
    v_mfma_f32_32x32x16_bf16 v[40:55], v[96:99], v[104:107], v[40:55]
    s_add_u32 m0, s49, 0
    s_nop 0
    buffer_load_dwordx4 v5, s[8:11], s48 offen lds
    v_lshlrev_b32 v36, 16, v98
    v_and_b32 v37, 0xffff0000, v98
    v_add_f32 v32, v32, v36
    v_add_f32 v33, v33, v37
    v_fmac_f32 v34, v36, v36
    v_fmac_f32 v35, v37, v37
    v_mfma_f32_32x32x16_bf16 v[56:71], v[96:99], v[108:111], v[56:71]
    s_add_u32 m0, s49, 1024
    s_nop 0
    buffer_load_dwordx4 v11, s[8:11], s48 offen lds
    s_add_u32 s48, s48, 128
    v_lshlrev_b32 v38, 16, v99
    v_and_b32 v39, 0xffff0000, v99
    v_add_f32 v32, v32, v38
    v_add_f32 v33, v33, v39
    v_fmac_f32 v34, v38, v38
    v_fmac_f32 v35, v39, v39
    v_mfma_f32_32x32x16_bf16 v[40:55], v[100:103], v[112:115], v[40:55]
    s_add_u32 m0, s28, 40960
    s_nop 0
    buffer_load_dwordx4 v4, s[12:15], s34 offen lds
    s_add_u32 s34, s34, s33
    v_lshlrev_b32 v36, 16, v102
    v_and_b32 v37, 0xffff0000, v102
    v_add_f32 v32, v32, v36
    v_add_f32 v33, v33, v37
    v_fmac_f32 v34, v36, v36
    v_fmac_f32 v35, v37, v37
    v_mfma_f32_32x32x16_bf16 v[56:71], v[100:103], v[116:119], v[56:71]
    v_lshlrev_b32 v38, 16, v103
    v_and_b32 v39, 0xffff0000, v103
    v_add_f32 v32, v32, v38
    v_add_f32 v33, v33, v39
    v_fmac_f32 v34, v38, v38
    v_fmac_f32 v35, v39, v39
    s_cbranch_vccz L_qad_ns1
    v_mfma_f32_16x16x32_bf16 v[16:19], v[104:107], v[20:23], v[16:19]
    v_mfma_f32_16x16x32_bf16 v[16:19], v[112:115], v[20:23], v[16:19]
L_qad_ns1:
    s_waitcnt lgkmcnt(0)
    s_waitcnt vmcnt(4)
    s_barrier
    ds_read_b128 v[96:99], v14 offset:16384
    ds_read_b64_tr_b16 v[104:105], v6 offset:24576
    ds_read_b64_tr_b16 v[106:107], v6 offset:25600
    ds_read_b64_tr_b16 v[108:109], v7 offset:24576
    ds_read_b64_tr_b16 v[110:111], v7 offset:25600
    ds_read_b128 v[100:103], v15 offset:16384
    ds_read_b64_tr_b16 v[112:113], v6 offset:28672
    ds_read_b64_tr_b16 v[114:115], v6 offset:29696
    ds_read_b64_tr_b16 v[116:117], v7 offset:28672
    ds_read_b64_tr_b16 v[118:119], v7 offset:29696
    v_mfma_f32_32x32x16_bf16 v[40:55], v[72:75], v[80:83], v[40:55]
    s_add_u32 m0, s28, 49152
    s_nop 0
    buffer_load_dwordx4 v4, s[12:15], s34 offen lds
    s_add_u32 s34, s34, s33
    v_lshlrev_b32 v36, 16, v74
    v_and_b32 v37, 0xffff0000, v74
    v_add_f32 v32, v32, v36
    v_add_f32 v33, v33, v37
    v_fmac_f32 v34, v36, v36
    v_fmac_f32 v35, v37, v37
    v_mfma_f32_32x32x16_bf16 v[56:71], v[72:75], v[84:87], v[56:71]
    v_lshlrev_b32 v38, 16, v75
    v_and_b32 v39, 0xffff0000, v75
    v_add_f32 v32, v32, v38
    v_add_f32 v33, v33, v39
    v_fmac_f32 v34, v38, v38
    v_fmac_f32 v35, v39, v39
    v_mfma_f32_32x32x16_bf16 v[40:55], v[76:79], v[88:91], v[40:55]
    v_lshlrev_b32 v36, 16, v78
    v_and_b32 v37, 0xffff0000, v78
    v_add_f32 v32, v32, v36
    v_add_f32 v33, v33, v37
    v_fmac_f32 v34, v36, v36
    v_fmac_f32 v35, v37, v37
    v_mfma_f32_32x32x16_bf16 v[56:71], v[76:79], v[92:95], v[56:71]
    v_lshlrev_b32 v38, 16, v79
    v_and_b32 v39, 0xffff0000, v79
    v_add_f32 v32, v32, v38
    v_add_f32 v33, v33, v39
    v_fmac_f32 v34, v38, v38
    v_fmac_f32 v35, v39, v39
    s_cbranch_vccz L_qad_ns2
    v_mfma_f32_16x16x32_bf16 v[16:19], v[80:83], v[20:23], v[16:19]
    v_mfma_f32_16x16x32_bf16 v[16:19], v[88:91], v[20:23], v[16:19]
L_qad_ns2:
    s_waitcnt lgkmcnt(0)
    s_waitcnt vmcnt(1)
    s_barrier
    ds_read_b128 v[72:75], v8 offset:0
    ds_read_b64_tr_b16 v[80:81], v6 offset:0
    ds_read_b64_tr_b16 v[82:83], v6 offset:1024
    ds_read_b64_tr_b16 v[84:85], v7 offset:0
    ds_read_b64_tr_b16 v[86:87], v7 offset:1024
    ds_read_b128 v[76:79], v9 offset:0
    ds_read_b64_tr_b16 v[88:89], v6 offset:4096
    ds_read_b64_tr_b16 v[90:91], v6 offset:5120
    ds_read_b64_tr_b16 v[92:93], v7 offset:4096
    ds_read_b64_tr_b16 v[94:95], v7 offset:5120
    v_mfma_f32_32x32x16_bf16 v[40:55], v[96:99], v[104:107], v[40:55]
    s_add_u32 m0, s49, 16384
    s_nop 0
    buffer_load_dwordx4 v5, s[8:11], s48 offen lds
    v_lshlrev_b32 v36, 16, v98
    v_and_b32 v37, 0xffff0000, v98
    v_add_f32 v32, v32, v36
    v_add_f32 v33, v33, v37
    v_fmac_f32 v34, v36, v36
    v_fmac_f32 v35, v37, v37
    v_mfma_f32_32x32x16_bf16 v[56:71], v[96:99], v[108:111], v[56:71]
    s_add_u32 m0, s49, 17408
    s_nop 0
    buffer_load_dwordx4 v11, s[8:11], s48 offen lds
    s_add_u32 s48, s48, 128
    v_lshlrev_b32 v38, 16, v99
    v_and_b32 v39, 0xffff0000, v99
    v_add_f32 v32, v32, v38
    v_add_f32 v33, v33, v39
    v_fmac_f32 v34, v38, v38
    v_fmac_f32 v35, v39, v39
    v_mfma_f32_32x32x16_bf16 v[40:55], v[100:103], v[112:115], v[40:55]
    s_add_u32 m0, s28, 57344
    s_nop 0
    buffer_load_dwordx4 v4, s[12:15], s34 offen lds
    s_add_u32 s34, s34, s33
    v_lshlrev_b32 v36, 16, v102
    v_and_b32 v37, 0xffff0000, v102
    v_add_f32 v32, v32, v36
    v_add_f32 v33, v33, v37
    v_fmac_f32 v34, v36, v36
    v_fmac_f32 v35, v37, v37
    v_mfma_f32_32x32x16_bf16 v[56:71], v[100:103], v[116:119], v[56:71]
    v_lshlrev_b32 v38, 16, v103
    v_and_b32 v39, 0xffff0000, v103
    v_add_f32 v32, v32, v38
    v_add_f32 v33, v33, v39
    v_fmac_f32 v34, v38, v38
    v_fmac_f32 v35, v39, v39
    s_cbranch_vccz L_qad_ns3
    v_mfma_f32_16x16x32_bf16 v[16:19], v[104:107], v[20:23], v[16:19]
    v_mfma_f32_16x16x32_bf16 v[16:19], v[112:115], v[20:23], v[16:19]
L_qad_ns3:
    s_add_u32 s42, s42, 1
    s_cmp_lt_u32 s42, 4
    s_cbranch_scc1 L_qad_loop
    s_waitcnt lgkmcnt(0)
    s_waitcnt vmcnt(3)
    s_barrier
    ds_read_b128 v[96:99], v14 offset:0
    ds_read_b64_tr_b16 v[104:105], v6 offset:8192
    ds_read_b64_tr_b16 v[106:107], v6 offset:9216
    ds_read_b64_tr_b16 v[108:109], v7 offset:8192
    ds_read_b64_tr_b16 v[110:111], v7 offset:9216
    ds_read_b128 v[100:103], v15 offset:0
    ds_read_b64_tr_b16 v[112:113], v6 offset:12288
    ds_read_b64_tr_b16 v[114:115], v6 offset:13312
    ds_read_b64_tr_b16 v[116:117], v7 offset:12288
    ds_read_b64_tr_b16 v[118:119], v7 offset:13312
    v_mfma_f32_32x32x16_bf16 v[40:55], v[72:75], v[80:83], v[40:55]
    v_lshlrev_b32 v36, 16, v74
    v_and_b32 v37, 0xffff0000, v74
    v_add_f32 v32, v32, v36
    v_add_f32 v33, v33, v37
    v_fmac_f32 v34, v36, v36
    v_fmac_f32 v35, v37, v37
    v_mfma_f32_32x32x16_bf16 v[56:71], v[72:75], v[84:87], v[56:71]
    v_lshlrev_b32 v38, 16, v75
    v_and_b32 v39, 0xffff0000, v75
    v_add_f32 v32, v32, v38
    v_add_f32 v33, v33, v39
    v_fmac_f32 v34, v38, v38
    v_fmac_f32 v35, v39, v39
    v_mfma_f32_32x32x16_bf16 v[40:55], v[76:79], v[88:91], v[40:55]
    v_lshlrev_b32 v36, 16, v78
    v_and_b32 v37, 0xffff0000, v78
    v_add_f32 v32, v32, v36
    v_add_f32 v33, v33, v37
    v_fmac_f32 v34, v36, v36
    v_fmac_f32 v35, v37, v37
    v_mfma_f32_32x32x16_bf16 v[56:71], v[76:79], v[92:95], v[56:71]
    v_lshlrev_b32 v38, 16, v79
    v_and_b32 v39, 0xffff0000, v79
    v_add_f32 v32, v32, v38
    v_add_f32 v33, v33, v39
    v_fmac_f32 v34, v38, v38
    v_fmac_f32 v35, v39, v39
    s_cbranch_vccz L_qad_ns16
    v_mfma_f32_16x16x32_bf16 v[16:19], v[80:83], v[20:23], v[16:19]
    v_mfma_f32_16x16x32_bf16 v[16:19], v[88:91], v[20:23], v[16:19]
L_qad_ns16:
    s_waitcnt lgkmcnt(0)
    s_waitcnt vmcnt(0)
    s_barrier
    ds_read_b128 v[72:75], v8 offset:16384
    ds_read_b64_tr_b16 v[80:81], v6 offset:16384
    ds_read_b64_tr_b16 v[82:83], v6 offset:17408
    ds_read_b64_tr_b16 v[84:85], v7 offset:16384
    ds_read_b64_tr_b16 v[86:87], v7 offset:17408
    ds_read_b128 v[76:79], v9 offset:16384
    ds_read_b64_tr_b16 v[88:89], v6 offset:20480
    ds_read_b64_tr_b16 v[90:91], v6 offset:21504
    ds_read_b64_tr_b16 v[92:93], v7 offset:20480
    ds_read_b64_tr_b16 v[94:95], v7 offset:21504
    v_mfma_f32_32x32x16_bf16 v[40:55], v[96:99], v[104:107], v[40:55]
    v_lshlrev_b32 v36, 16, v98
    v_and_b32 v37, 0xffff0000, v98
    v_add_f32 v32, v32, v36
    v_add_f32 v33, v33, v37
    v_fmac_f32 v34, v36, v36
    v_fmac_f32 v35, v37, v37
    v_mfma_f32_32x32x16_bf16 v[56:71], v[96:99], v[108:111], v[56:71]
    v_lshlrev_b32 v38, 16, v99
    v_and_b32 v39, 0xffff0000, v99
    v_add_f32 v32, v32, v38
    v_add_f32 v33, v33, v39
    v_fmac_f32 v34, v38, v38
    v_fmac_f32 v35, v39, v39
    v_mfma_f32_32x32x16_bf16 v[40:55], v[100:103], v[112:115], v[40:55]
    v_lshlrev_b32 v36, 16, v102
    v_and_b32 v37, 0xffff0000, v102
    v_add_f32 v32, v32, v36
    v_add_f32 v33, v33, v37
    v_fmac_f32 v34, v36, v36
    v_fmac_f32 v35, v37, v37
    v_mfma_f32_32x32x16_bf16 v[56:71], v[100:103], v[116:119], v[56:71]
    v_lshlrev_b32 v38, 16, v103
    v_and_b32 v39, 0xffff0000, v103
    v_add_f32 v32, v32, v38
    v_add_f32 v33, v33, v39
    v_fmac_f32 v34, v38, v38
    v_fmac_f32 v35, v39, v39
    s_cbranch_vccz L_qad_ns17
    v_mfma_f32_16x16x32_bf16 v[16:19], v[104:107], v[20:23], v[16:19]
    v_mfma_f32_16x16x32_bf16 v[16:19], v[112:115], v[20:23], v[16:19]
L_qad_ns17:
    s_waitcnt lgkmcnt(0)
    s_waitcnt vmcnt(0)
    s_barrier
    ds_read_b128 v[96:99], v14 offset:16384
    ds_read_b64_tr_b16 v[104:105], v6 offset:24576
    ds_read_b64_tr_b16 v[106:107], v6 offset:25600
    ds_read_b64_tr_b16 v[108:109], v7 offset:24576
    ds_read_b64_tr_b16 v[110:111], v7 offset:25600
    ds_read_b128 v[100:103], v15 offset:16384
    ds_read_b64_tr_b16 v[112:113], v6 offset:28672
    ds_read_b64_tr_b16 v[114:115], v6 offset:29696
    ds_read_b64_tr_b16 v[116:117], v7 offset:28672
    ds_read_b64_tr_b16 v[118:119], v7 offset:29696
    v_mfma_f32_32x32x16_bf16 v[40:55], v[72:75], v[80:83], v[40:55]
    v_lshlrev_b32 v36, 16, v74
    v_and_b32 v37, 0xffff0000, v74
    v_add_f32 v32, v32, v36
    v_add_f32 v33, v33, v37
    v_fmac_f32 v34, v36, v36
    v_fmac_f32 v35, v37, v37
    v_mfma_f32_32x32x16_bf16 v[56:71], v[72:75], v[84:87], v[56:71]
    v_lshlrev_b32 v38, 16, v75
    v_and_b32 v39, 0xffff0000, v75
    v_add_f32 v32, v32, v38
    v_add_f32 v33, v33, v39
    v_fmac_f32 v34, v38, v38
    v_fmac_f32 v35, v39, v39
    v_mfma_f32_32x32x16_bf16 v[40:55], v[76:79], v[88:91], v[40:55]
    v_lshlrev_b32 v36, 16, v78
    v_and_b32 v37, 0xffff0000, v78
    v_add_f32 v32, v32, v36
    v_add_f32 v33, v33, v37
    v_fmac_f32 v34, v36, v36
    v_fmac_f32 v35, v37, v37
    v_mfma_f32_32x32x16_bf16 v[56:71], v[76:79], v[92:95], v[56:71]
    v_lshlrev_b32 v38, 16, v79
    v_and_b32 v39, 0xffff0000, v79
    v_add_f32 v32, v32, v38
    v_add_f32 v33, v33, v39
    v_fmac_f32 v34, v38, v38
    v_fmac_f32 v35, v39, v39
    s_cbranch_vccz L_qad_ns18
    v_mfma_f32_16x16x32_bf16 v[16:19], v[80:83], v[20:23], v[16:19]
    v_mfma_f32_16x16x32_bf16 v[16:19], v[88:91], v[20:23], v[16:19]
L_qad_ns18:
    s_waitcnt lgkmcnt(0)
    v_mfma_f32_32x32x16_bf16 v[40:55], v[96:99], v[104:107], v[40:55]
    v_lshlrev_b32 v36, 16, v98
    v_and_b32 v37, 0xffff0000, v98
    v_add_f32 v32, v32, v36
    v_add_f32 v33, v33, v37
    v_fmac_f32 v34, v36, v36
    v_fmac_f32 v35, v37, v37
    v_mfma_f32_32x32x16_bf16 v[56:71], v[96:99], v[108:111], v[56:71]
    v_lshlrev_b32 v38, 16, v99
    v_and_b32 v39, 0xffff0000, v99
    v_add_f32 v32, v32, v38
    v_add_f32 v33, v33, v39
    v_fmac_f32 v34, v38, v38
    v_fmac_f32 v35, v39, v39
    v_mfma_f32_32x32x16_bf16 v[40:55], v[100:103], v[112:115], v[40:55]
    v_lshlrev_b32 v36, 16, v102
    v_and_b32 v37, 0xffff0000, v102
    v_add_f32 v32, v32, v36
    v_add_f32 v33, v33, v37
    v_fmac_f32 v34, v36, v36
    v_fmac_f32 v35, v37, v37
    v_mfma_f32_32x32x16_bf16 v[56:71], v[100:103], v[116:119], v[56:71]
    v_lshlrev_b32 v38, 16, v103
    v_and_b32 v39, 0xffff0000, v103
    v_add_f32 v32, v32, v38
    v_add_f32 v33, v33, v39
    v_fmac_f32 v34, v38, v38
    v_fmac_f32 v35, v39, v39
    s_cbranch_vccz L_qad_ns19
    v_mfma_f32_16x16x32_bf16 v[16:19], v[104:107], v[20:23], v[16:19]
    v_mfma_f32_16x16x32_bf16 v[16:19], v[112:115], v[20:23], v[16:19]
L_qad_ns19:
L_qa_post:
    s_nop 7
    v_add_f32 v32, v32, v33
    v_add_f32 v33, v34, v35
    v_mov_b32 v24, v32
    v_mov_b32 v25, v32
    s_nop 1
    v_permlane32_swap_b32 v24, v25
    s_nop 1
    v_add_f32 v32, v24, v25
    v_mov_b32 v24, v33
    v_mov_b32 v25, v33
    s_nop 1
    v_permlane32_swap_b32 v24, v25
    s_nop 1
    v_add_f32 v33, v24, v25
    s_lshl_b32 s37, s25, 10
    s_lshl_b32 s38, s24, 8
    s_add_u32 s38, s38, 69632
    s_add_u32 s37, s37, s38
    v_lshl_add_u32 v26, v3, 3, s37
    ds_write_b64 v26, v[32:33]
    s_cmp_lt_u32 s24, 2
    s_cbranch_scc0 L_qa_nocs
    s_lshl_b32 s37, s23, 8
    s_add_u32 s37, s37, 67584
    v_and_b32 v24, 15, v2
    v_lshrrev_b32 v25, 4, v2
    v_lshlrev_b32 v26, 6, v24
    v_lshl_add_u32 v26, v25, 4, v26
    v_add_u32 v26, s37, v26
    v_cmp_gt_u32 vcc, 4, v24
    s_and_saveexec_b64 s[54:55], vcc
    ds_write_b128 v26, v[16:19]
    s_mov_b64 exec, s[54:55]
    v_lshl_add_u32 v26, v3, 2, s37
    s_waitcnt lgkmcnt(0)
    ds_read_b32 v24, v26
    ds_read_b32 v25, v26 offset:128
    s_waitcnt lgkmcnt(0)
    v_add_f32 v36, v24, v25
    s_lshl_b32 s37, s40, 7
    s_add_u32 s37, s37, 66560
    v_lshl_add_u32 v30, v3, 2, s37
    ds_write_b32 v30, v36
L_qa_nocs:
    s_waitcnt lgkmcnt(0)
    s_barrier
    s_xor_b32 s37, s25, 1
    s_lshl_b32 s37, s37, 10
    s_add_u32 s37, s37, s38
    v_lshl_add_u32 v26, v3, 3, s37
    ds_read_b64 v[28:29], v26
    s_waitcnt lgkmcnt(0)
    v_add_f32 v32, v32, v28
    v_add_f32 v33, v33, v29
    v_mul_f32 v38, 0x3acccccd, v32
    v_mul_f32 v39, 0x3acccccd, v33
    v_fma_f32 v39, -v38, v38, v39
    v_max_f32 v39, 0, v39
    v_mov_b32 v24, v38
    v_mov_b32 v25, v39
    v_mov_b32 v26, v24
    v_cvt_pk_bf16_f32 v26, v26, v26
    v_and_b32 v26, 0xffff0000, v26
    v_mov_b32 v27, v25
    v_cvt_pk_bf16_f32 v27, v27, v27
    v_and_b32 v27, 0xffff0000, v27
    v_add_f32 v27, 0x3727c5ac, v27
    v_cvt_pk_bf16_f32 v27, v27, v27
    v_and_b32 v27, 0xffff0000, v27
    v_sqrt_f32 v27, v27
    s_nop 0
    v_cvt_pk_bf16_f32 v27, v27, v27
    v_and_b32 v27, 0xffff0000, v27
    v_rcp_f32 v28, v27
    s_nop 0
    v_mul_f32 v29, v26, v28
    s_cmp_eq_u32 s22, 0
    s_cbranch_scc0 L_qa_rs_nq
    v_mul_f32 v28, 0x3ea52b5c, v28
    v_mul_f32 v29, 0x3ea52b5c, v29
L_qa_rs_nq:
    s_lshl_b32 s37, s24, 7
    s_add_u32 s37, s37, 65536
    v_lshl_add_u32 v30, v3, 2, s37
    ds_write_b32 v30, v28
    ds_write_b32 v30, v29 offset:512
    s_waitcnt lgkmcnt(0)
    s_cmp_lg_u32 s22, 0
    s_cbranch_scc1 L_qa_nt0
    s_lshl_b32 s37, s24, 7
    s_add_u32 s37, s37, 65536
    v_lshl_add_u32 v28, v3, 2, s37
    ds_read_b32 v24, v28
    ds_read_b32 v26, v28 offset:512
    s_lshl_b32 s38, s20, 7
    s_lshl_b32 s39, s24, 5
    s_add_u32 s38, s38, s39
    v_add_u32 v29, s38, v3
    v_and_b32 v33, 1, v2
    v_lshlrev_b32 v30, 3, v29
    v_lshl_add_u32 v30, v1, 14, v30
    v_mul_u32_u24 v31, 32760, v33
    v_add_u32 v30, v30, v31
    v_lshlrev_b32 v32, 4, v1
    v_add_u32 v32, 66560, v32
    s_lshl_b32 s37, s40, 7
    v_add_u32 v33, s37, v32
    ds_read_b128 v[72:75], v33 offset:0
    ds_read_b128 v[76:79], v33 offset:32
    ds_read_b128 v[80:83], v33 offset:64
    ds_read_b128 v[84:87], v33 offset:96
    s_waitcnt lgkmcnt(0)
    v_pk_mul_f32 v[72:73], v[72:73], v[26:27] op_sel_hi:[1,0]
    v_pk_fma_f32 v[40:41], v[40:41], v[24:25], v[72:73] op_sel_hi:[1,0,1] neg_lo:[0,0,1] neg_hi:[0,0,1]
    v_pk_mul_f32 v[74:75], v[74:75], v[26:27] op_sel_hi:[1,0]
    v_pk_fma_f32 v[42:43], v[42:43], v[24:25], v[74:75] op_sel_hi:[1,0,1] neg_lo:[0,0,1] neg_hi:[0,0,1]
    v_pk_mul_f32 v[76:77], v[76:77], v[26:27] op_sel_hi:[1,0]
    v_pk_fma_f32 v[44:45], v[44:45], v[24:25], v[76:77] op_sel_hi:[1,0,1] neg_lo:[0,0,1] neg_hi:[0,0,1]
    v_pk_mul_f32 v[78:79], v[78:79], v[26:27] op_sel_hi:[1,0]
    v_pk_fma_f32 v[46:47], v[46:47], v[24:25], v[78:79] op_sel_hi:[1,0,1] neg_lo:[0,0,1] neg_hi:[0,0,1]
    v_pk_mul_f32 v[80:81], v[80:81], v[26:27] op_sel_hi:[1,0]
    v_pk_fma_f32 v[48:49], v[48:49], v[24:25], v[80:81] op_sel_hi:[1,0,1] neg_lo:[0,0,1] neg_hi:[0,0,1]
    v_pk_mul_f32 v[82:83], v[82:83], v[26:27] op_sel_hi:[1,0]
    v_pk_fma_f32 v[50:51], v[50:51], v[24:25], v[82:83] op_sel_hi:[1,0,1] neg_lo:[0,0,1] neg_hi:[0,0,1]
    v_pk_mul_f32 v[84:85], v[84:85], v[26:27] op_sel_hi:[1,0]
    v_pk_fma_f32 v[52:53], v[52:53], v[24:25], v[84:85] op_sel_hi:[1,0,1] neg_lo:[0,0,1] neg_hi:[0,0,1]
    v_pk_mul_f32 v[86:87], v[86:87], v[26:27] op_sel_hi:[1,0]
    v_pk_fma_f32 v[54:55], v[54:55], v[24:25], v[86:87] op_sel_hi:[1,0,1] neg_lo:[0,0,1] neg_hi:[0,0,1]
    v_cvt_pk_bf16_f32 v104, v40, v41
    v_cvt_pk_bf16_f32 v105, v42, v43
    v_cvt_pk_bf16_f32 v106, v44, v45
    v_cvt_pk_bf16_f32 v107, v46, v47
    v_cvt_pk_bf16_f32 v108, v48, v49
    v_cvt_pk_bf16_f32 v109, v50, v51
    v_cvt_pk_bf16_f32 v110, v52, v53
    v_cvt_pk_bf16_f32 v111, v54, v55
    s_mov_b32 vcc_lo, 0xaaaaaaaa
    s_mov_b32 vcc_hi, 0xaaaaaaaa
    v_mov_b32_dpp v38, v106 quad_perm:[1,0,3,2] row_mask:0xf bank_mask:0xf
    v_mov_b32_dpp v39, v107 quad_perm:[1,0,3,2] row_mask:0xf bank_mask:0xf
    v_cndmask_b32_dpp v106, v104, v106, vcc quad_perm:[1,0,3,2] row_mask:0xf bank_mask:0xf
    v_cndmask_b32_dpp v107, v105, v107, vcc quad_perm:[1,0,3,2] row_mask:0xf bank_mask:0xf
    v_cndmask_b32 v104, v104, v38, vcc
    v_cndmask_b32 v105, v105, v39, vcc
    v_mov_b32_dpp v38, v110 quad_perm:[1,0,3,2] row_mask:0xf bank_mask:0xf
    v_mov_b32_dpp v39, v111 quad_perm:[1,0,3,2] row_mask:0xf bank_mask:0xf
    v_cndmask_b32_dpp v110, v108, v110, vcc quad_perm:[1,0,3,2] row_mask:0xf bank_mask:0xf
    v_cndmask_b32_dpp v111, v109, v111, vcc quad_perm:[1,0,3,2] row_mask:0xf bank_mask:0xf
    v_cndmask_b32 v108, v108, v38, vcc
    v_cndmask_b32 v109, v109, v39, vcc
    s_lshl_b32 s37, s40, 3
    s_add_u32 s37, s37, s35
    s_lshl_b32 s37, s37, 14
    buffer_store_dwordx4 v[104:107], v30, s[16:19], s37 offen sc1
    s_add_u32 s37, s37, 65536
    buffer_store_dwordx4 v[108:111], v30, s[16:19], s37 offen sc1
    s_nop 1
    s_lshl_b32 s37, s41, 7
    v_add_u32 v33, s37, v32
    ds_read_b128 v[72:75], v33 offset:0
    ds_read_b128 v[76:79], v33 offset:32
    ds_read_b128 v[80:83], v33 offset:64
    ds_read_b128 v[84:87], v33 offset:96
    s_waitcnt lgkmcnt(0)
    v_pk_mul_f32 v[72:73], v[72:73], v[26:27] op_sel_hi:[1,0]
    v_pk_fma_f32 v[56:57], v[56:57], v[24:25], v[72:73] op_sel_hi:[1,0,1] neg_lo:[0,0,1] neg_hi:[0,0,1]
    v_pk_mul_f32 v[74:75], v[74:75], v[26:27] op_sel_hi:[1,0]
    v_pk_fma_f32 v[58:59], v[58:59], v[24:25], v[74:75] op_sel_hi:[1,0,1] neg_lo:[0,0,1] neg_hi:[0,0,1]
    v_pk_mul_f32 v[76:77], v[76:77], v[26:27] op_sel_hi:[1,0]
    v_pk_fma_f32 v[60:61], v[60:61], v[24:25], v[76:77] op_sel_hi:[1,0,1] neg_lo:[0,0,1] neg_hi:[0,0,1]
    v_pk_mul_f32 v[78:79], v[78:79], v[26:27] op_sel_hi:[1,0]
    v_pk_fma_f32 v[62:63], v[62:63], v[24:25], v[78:79] op_sel_hi:[1,0,1] neg_lo:[0,0,1] neg_hi:[0,0,1]
    v_pk_mul_f32 v[80:81], v[80:81], v[26:27] op_sel_hi:[1,0]
    v_pk_fma_f32 v[64:65], v[64:65], v[24:25], v[80:81] op_sel_hi:[1,0,1] neg_lo:[0,0,1] neg_hi:[0,0,1]
    v_pk_mul_f32 v[82:83], v[82:83], v[26:27] op_sel_hi:[1,0]
    v_pk_fma_f32 v[66:67], v[66:67], v[24:25], v[82:83] op_sel_hi:[1,0,1] neg_lo:[0,0,1] neg_hi:[0,0,1]
    v_pk_mul_f32 v[84:85], v[84:85], v[26:27] op_sel_hi:[1,0]
    v_pk_fma_f32 v[68:69], v[68:69], v[24:25], v[84:85] op_sel_hi:[1,0,1] neg_lo:[0,0,1] neg_hi:[0,0,1]
    v_pk_mul_f32 v[86:87], v[86:87], v[26:27] op_sel_hi:[1,0]
    v_pk_fma_f32 v[70:71], v[70:71], v[24:25], v[86:87] op_sel_hi:[1,0,1] neg_lo:[0,0,1] neg_hi:[0,0,1]
    v_cvt_pk_bf16_f32 v104, v56, v57
    v_cvt_pk_bf16_f32 v105, v58, v59
    v_cvt_pk_bf16_f32 v106, v60, v61
    v_cvt_pk_bf16_f32 v107, v62, v63
    v_cvt_pk_bf16_f32 v108, v64, v65
    v_cvt_pk_bf16_f32 v109, v66, v67
    v_cvt_pk_bf16_f32 v110, v68, v69
    v_cvt_pk_bf16_f32 v111, v70, v71
    s_mov_b32 vcc_lo, 0xaaaaaaaa
    s_mov_b32 vcc_hi, 0xaaaaaaaa
    v_mov_b32_dpp v38, v106 quad_perm:[1,0,3,2] row_mask:0xf bank_mask:0xf
    v_mov_b32_dpp v39, v107 quad_perm:[1,0,3,2] row_mask:0xf bank_mask:0xf
    v_cndmask_b32_dpp v106, v104, v106, vcc quad_perm:[1,0,3,2] row_mask:0xf bank_mask:0xf
    v_cndmask_b32_dpp v107, v105, v107, vcc quad_perm:[1,0,3,2] row_mask:0xf bank_mask:0xf
    v_cndmask_b32 v104, v104, v38, vcc
    v_cndmask_b32 v105, v105, v39, vcc
    v_mov_b32_dpp v38, v110 quad_perm:[1,0,3,2] row_mask:0xf bank_mask:0xf
    v_mov_b32_dpp v39, v111 quad_perm:[1,0,3,2] row_mask:0xf bank_mask:0xf
    v_cndmask_b32_dpp v110, v108, v110, vcc quad_perm:[1,0,3,2] row_mask:0xf bank_mask:0xf
    v_cndmask_b32_dpp v111, v109, v111, vcc quad_perm:[1,0,3,2] row_mask:0xf bank_mask:0xf
    v_cndmask_b32 v108, v108, v38, vcc
    v_cndmask_b32 v109, v109, v39, vcc
    s_lshl_b32 s37, s41, 3
    s_add_u32 s37, s37, s35
    s_lshl_b32 s37, s37, 14
    buffer_store_dwordx4 v[104:107], v30, s[16:19], s37 offen sc1
    s_add_u32 s37, s37, 65536
    buffer_store_dwordx4 v[108:111], v30, s[16:19], s37 offen sc1
    s_nop 1
    s_branch L_qa_pub
L_qa_nt0:
    s_cmp_lg_u32 s22, 1
    s_cbranch_scc1 L_qa_nt1
    s_lshl_b32 s37, s24, 7
    s_add_u32 s37, s37, 65536
    v_lshl_add_u32 v28, v3, 2, s37
    ds_read_b32 v24, v28
    ds_read_b32 v26, v28 offset:512
    s_lshl_b32 s38, s20, 7
    s_lshl_b32 s39, s24, 5
    s_add_u32 s38, s38, s39
    v_add_u32 v29, s38, v3
    v_and_b32 v33, 1, v2
    s_lshr_b32 s39, s38, 5
    s_mul_i32 s39, s39, 3072
    v_and_b32 v30, 30, v3
    v_lshl_add_u32 v30, v30, 3, s39
    v_lshl_add_u32 v31, v33, 1, v1
    v_mov_b32 v12, 0x3f80
    v_mov_b32 v13, 0
    v_mov_b32 v14, 0x3f80
    v_mov_b32 v15, 0
    v_lshlrev_b32 v32, 4, v1
    v_add_u32 v32, 66560, v32
    s_lshl_b32 s37, s40, 7
    v_add_u32 v33, s37, v32
    ds_read_b128 v[72:75], v33 offset:0
    ds_read_b128 v[76:79], v33 offset:32
    ds_read_b128 v[80:83], v33 offset:64
    ds_read_b128 v[84:87], v33 offset:96
    s_waitcnt lgkmcnt(0)
    v_pk_mul_f32 v[72:73], v[72:73], v[26:27] op_sel_hi:[1,0]
    v_pk_fma_f32 v[40:41], v[40:41], v[24:25], v[72:73] op_sel_hi:[1,0,1] neg_lo:[0,0,1] neg_hi:[0,0,1]
    v_pk_mul_f32 v[74:75], v[74:75], v[26:27] op_sel_hi:[1,0]
    v_pk_fma_f32 v[42:43], v[42:43], v[24:25], v[74:75] op_sel_hi:[1,0,1] neg_lo:[0,0,1] neg_hi:[0,0,1]
    v_pk_mul_f32 v[76:77], v[76:77], v[26:27] op_sel_hi:[1,0]
    v_pk_fma_f32 v[44:45], v[44:45], v[24:25], v[76:77] op_sel_hi:[1,0,1] neg_lo:[0,0,1] neg_hi:[0,0,1]
    v_pk_mul_f32 v[78:79], v[78:79], v[26:27] op_sel_hi:[1,0]
    v_pk_fma_f32 v[46:47], v[46:47], v[24:25], v[78:79] op_sel_hi:[1,0,1] neg_lo:[0,0,1] neg_hi:[0,0,1]
    v_pk_mul_f32 v[80:81], v[80:81], v[26:27] op_sel_hi:[1,0]
    v_pk_fma_f32 v[48:49], v[48:49], v[24:25], v[80:81] op_sel_hi:[1,0,1] neg_lo:[0,0,1] neg_hi:[0,0,1]
    v_pk_mul_f32 v[82:83], v[82:83], v[26:27] op_sel_hi:[1,0]
    v_pk_fma_f32 v[50:51], v[50:51], v[24:25], v[82:83] op_sel_hi:[1,0,1] neg_lo:[0,0,1] neg_hi:[0,0,1]
    v_pk_mul_f32 v[84:85], v[84:85], v[26:27] op_sel_hi:[1,0]
    v_pk_fma_f32 v[52:53], v[52:53], v[24:25], v[84:85] op_sel_hi:[1,0,1] neg_lo:[0,0,1] neg_hi:[0,0,1]
    v_pk_mul_f32 v[86:87], v[86:87], v[26:27] op_sel_hi:[1,0]
    v_pk_fma_f32 v[54:55], v[54:55], v[24:25], v[86:87] op_sel_hi:[1,0,1] neg_lo:[0,0,1] neg_hi:[0,0,1]
    v_cvt_pk_bf16_f32 v104, v40, v41
    v_cvt_pk_bf16_f32 v105, v42, v43
    v_cvt_pk_bf16_f32 v106, v44, v45
    v_cvt_pk_bf16_f32 v107, v46, v47
    v_cvt_pk_bf16_f32 v108, v48, v49
    v_cvt_pk_bf16_f32 v109, v50, v51
    v_cvt_pk_bf16_f32 v110, v52, v53
    v_cvt_pk_bf16_f32 v111, v54, v55
    s_mov_b32 vcc_lo, 0xaaaaaaaa
    s_mov_b32 vcc_hi, 0xaaaaaaaa
    v_mov_b32_dpp v38, v106 quad_perm:[1,0,3,2] row_mask:0xf bank_mask:0xf
    v_mov_b32_dpp v39, v107 quad_perm:[1,0,3,2] row_mask:0xf bank_mask:0xf
    v_cndmask_b32_dpp v106, v104, v106, vcc quad_perm:[1,0,3,2] row_mask:0xf bank_mask:0xf
    v_cndmask_b32_dpp v107, v105, v107, vcc quad_perm:[1,0,3,2] row_mask:0xf bank_mask:0xf
    v_cndmask_b32 v104, v104, v38, vcc
    v_cndmask_b32 v105, v105, v39, vcc
    v_mov_b32_dpp v38, v110 quad_perm:[1,0,3,2] row_mask:0xf bank_mask:0xf
    v_mov_b32_dpp v39, v111 quad_perm:[1,0,3,2] row_mask:0xf bank_mask:0xf
    v_cndmask_b32_dpp v110, v108, v110, vcc quad_perm:[1,0,3,2] row_mask:0xf bank_mask:0xf
    v_cndmask_b32_dpp v111, v109, v111, vcc quad_perm:[1,0,3,2] row_mask:0xf bank_mask:0xf
    v_cndmask_b32 v108, v108, v38, vcc
    v_cndmask_b32 v109, v109, v39, vcc
    s_lshl_b32 s39, s40, 3
    s_add_u32 s37, s35, s39
    v_add_u32 v34, s37, v31
    v_mul_u32_u24 v35, 205, v34
    v_lshrrev_b32 v35, 10, v35
    v_mul_u32_u24 v36, 5, v35
    v_sub_u32 v36, v34, v36
    v_mul_u32_u24 v37, 0x30000, v35
    v_lshl_add_u32 v37, v36, 8, v37
    v_add_u32 v37, v37, v30
    v_cmp_eq_u32 vcc, 4, v36
    buffer_store_dwordx4 v[104:107], v37, s[16:19], 0 offen sc1
    s_and_saveexec_b64 s[54:55], vcc
    s_cbranch_execz L_qa_e10_nc00
    buffer_store_dwordx4 v[12:15], v37, s[16:19], 0 offen offset:256 sc1
L_qa_e10_nc00:
    s_mov_b64 exec, s[54:55]
    v_add_u32 v34, s37, v31
    v_add_u32 v34, 4, v34
    v_mul_u32_u24 v35, 205, v34
    v_lshrrev_b32 v35, 10, v35
    v_mul_u32_u24 v36, 5, v35
    v_sub_u32 v36, v34, v36
    v_mul_u32_u24 v37, 0x30000, v35
    v_lshl_add_u32 v37, v36, 8, v37
    v_add_u32 v37, v37, v30
    v_cmp_eq_u32 vcc, 4, v36
    buffer_store_dwordx4 v[108:111], v37, s[16:19], 0 offen sc1
    s_and_saveexec_b64 s[54:55], vcc
    s_cbranch_execz L_qa_e10_nc01
    buffer_store_dwordx4 v[12:15], v37, s[16:19], 0 offen offset:256 sc1
L_qa_e10_nc01:
    s_mov_b64 exec, s[54:55]
    s_nop 1
    s_lshl_b32 s37, s41, 7
    v_add_u32 v33, s37, v32
    ds_read_b128 v[72:75], v33 offset:0
    ds_read_b128 v[76:79], v33 offset:32
    ds_read_b128 v[80:83], v33 offset:64
    ds_read_b128 v[84:87], v33 offset:96
    s_waitcnt lgkmcnt(0)
    v_pk_mul_f32 v[72:73], v[72:73], v[26:27] op_sel_hi:[1,0]
    v_pk_fma_f32 v[56:57], v[56:57], v[24:25], v[72:73] op_sel_hi:[1,0,1] neg_lo:[0,0,1] neg_hi:[0,0,1]
    v_pk_mul_f32 v[74:75], v[74:75], v[26:27] op_sel_hi:[1,0]
    v_pk_fma_f32 v[58:59], v[58:59], v[24:25], v[74:75] op_sel_hi:[1,0,1] neg_lo:[0,0,1] neg_hi:[0,0,1]
    v_pk_mul_f32 v[76:77], v[76:77], v[26:27] op_sel_hi:[1,0]
    v_pk_fma_f32 v[60:61], v[60:61], v[24:25], v[76:77] op_sel_hi:[1,0,1] neg_lo:[0,0,1] neg_hi:[0,0,1]
    v_pk_mul_f32 v[78:79], v[78:79], v[26:27] op_sel_hi:[1,0]
    v_pk_fma_f32 v[62:63], v[62:63], v[24:25], v[78:79] op_sel_hi:[1,0,1] neg_lo:[0,0,1] neg_hi:[0,0,1]
    v_pk_mul_f32 v[80:81], v[80:81], v[26:27] op_sel_hi:[1,0]
    v_pk_fma_f32 v[64:65], v[64:65], v[24:25], v[80:81] op_sel_hi:[1,0,1] neg_lo:[0,0,1] neg_hi:[0,0,1]
    v_pk_mul_f32 v[82:83], v[82:83], v[26:27] op_sel_hi:[1,0]
    v_pk_fma_f32 v[66:67], v[66:67], v[24:25], v[82:83] op_sel_hi:[1,0,1] neg_lo:[0,0,1] neg_hi:[0,0,1]
    v_pk_mul_f32 v[84:85], v[84:85], v[26:27] op_sel_hi:[1,0]
    v_pk_fma_f32 v[68:69], v[68:69], v[24:25], v[84:85] op_sel_hi:[1,0,1] neg_lo:[0,0,1] neg_hi:[0,0,1]
    v_pk_mul_f32 v[86:87], v[86:87], v[26:27] op_sel_hi:[1,0]
    v_pk_fma_f32 v[70:71], v[70:71], v[24:25], v[86:87] op_sel_hi:[1,0,1] neg_lo:[0,0,1] neg_hi:[0,0,1]
    v_cvt_pk_bf16_f32 v104, v56, v57
    v_cvt_pk_bf16_f32 v105, v58, v59
    v_cvt_pk_bf16_f32 v106, v60, v61
    v_cvt_pk_bf16_f32 v107, v62, v63
    v_cvt_pk_bf16_f32 v108, v64, v65
    v_cvt_pk_bf16_f32 v109, v66, v67
    v_cvt_pk_bf16_f32 v110, v68, v69
    v_cvt_pk_bf16_f32 v111, v70, v71
    s_mov_b32 vcc_lo, 0xaaaaaaaa
    s_mov_b32 vcc_hi, 0xaaaaaaaa
    v_mov_b32_dpp v38, v106 quad_perm:[1,0,3,2] row_mask:0xf bank_mask:0xf
    v_mov_b32_dpp v39, v107 quad_perm:[1,0,3,2] row_mask:0xf bank_mask:0xf
    v_cndmask_b32_dpp v106, v104, v106, vcc quad_perm:[1,0,3,2] row_mask:0xf bank_mask:0xf
    v_cndmask_b32_dpp v107, v105, v107, vcc quad_perm:[1,0,3,2] row_mask:0xf bank_mask:0xf
    v_cndmask_b32 v104, v104, v38, vcc
    v_cndmask_b32 v105, v105, v39, vcc
    v_mov_b32_dpp v38, v110 quad_perm:[1,0,3,2] row_mask:0xf bank_mask:0xf
    v_mov_b32_dpp v39, v111 quad_perm:[1,0,3,2] row_mask:0xf bank_mask:0xf
    v_cndmask_b32_dpp v110, v108, v110, vcc quad_perm:[1,0,3,2] row_mask:0xf bank_mask:0xf
    v_cndmask_b32_dpp v111, v109, v111, vcc quad_perm:[1,0,3,2] row_mask:0xf bank_mask:0xf
    v_cndmask_b32 v108, v108, v38, vcc
    v_cndmask_b32 v109, v109, v39, vcc
    s_lshl_b32 s39, s41, 3
    s_add_u32 s37, s35, s39
    v_add_u32 v34, s37, v31
    v_mul_u32_u24 v35, 205, v34
    v_lshrrev_b32 v35, 10, v35
    v_mul_u32_u24 v36, 5, v35
    v_sub_u32 v36, v34, v36
    v_mul_u32_u24 v37, 0x30000, v35
    v_lshl_add_u32 v37, v36, 8, v37
    v_add_u32 v37, v37, v30
    v_cmp_eq_u32 vcc, 4, v36
    buffer_store_dwordx4 v[104:107], v37, s[16:19], 0 offen sc1
    s_and_saveexec_b64 s[54:55], vcc
    s_cbranch_execz L_qa_e10_nc10
    buffer_store_dwordx4 v[12:15], v37, s[16:19], 0 offen offset:256 sc1
L_qa_e10_nc10:
    s_mov_b64 exec, s[54:55]
    v_add_u32 v34, s37, v31
    v_add_u32 v34, 4, v34
    v_mul_u32_u24 v35, 205, v34
    v_lshrrev_b32 v35, 10, v35
    v_mul_u32_u24 v36, 5, v35
    v_sub_u32 v36, v34, v36
    v_mul_u32_u24 v37, 0x30000, v35
    v_lshl_add_u32 v37, v36, 8, v37
    v_add_u32 v37, v37, v30
    v_cmp_eq_u32 vcc, 4, v36
    buffer_store_dwordx4 v[108:111], v37, s[16:19], 0 offen sc1
    s_and_saveexec_b64 s[54:55], vcc
    s_cbranch_execz L_qa_e10_nc11
    buffer_store_dwordx4 v[12:15], v37, s[16:19], 0 offen offset:256 sc1
L_qa_e10_nc11:
    s_mov_b64 exec, s[54:55]
    s_nop 1
    s_branch L_qa_pub
L_qa_nt1:
    s_cmp_lg_u32 s22, 2
    s_cbranch_scc1 L_qa_nt2
    s_lshl_b32 s37, s24, 7
    s_add_u32 s37, s37, 65536
    v_lshl_add_u32 v28, v1, 4, s37
    ds_read_b128 v[72:75], v28 offset:0
    ds_read_b128 v[88:91], v28 offset:512
    ds_read_b128 v[76:79], v28 offset:32
    ds_read_b128 v[92:95], v28 offset:544
    ds_read_b128 v[80:83], v28 offset:64
    ds_read_b128 v[96:99], v28 offset:576
    ds_read_b128 v[84:87], v28 offset:96
    ds_read_b128 v[100:103], v28 offset:608
    s_lshl_b32 s38, s20, 2
    s_add_u32 s38, s38, s24
    s_mul_i32 s38, s38, 3072
    s_add_u32 s38, s38, 1536
    v_mul_u32_u24 v29, 384, v1
    v_add_u32 v29, s38, v29
    v_lshlrev_b32 v32, 2, v3
    v_add_u32 v32, 66560, v32
    s_lshl_b32 s37, s40, 7
    v_add_u32 v33, s37, v32
    ds_read_b32 v24, v33
    s_lshl_b32 s37, s35, 2
    s_lshl_b32 s39, s40, 5
    s_add_u32 s37, s37, s39
    v_add_u32 v34, s37, v3
    v_mul_u32_u24 v35, 3277, v34
    v_lshrrev_b32 v35, 16, v35
    v_mul_u32_u24 v36, 20, v35
    v_sub_u32 v36, v34, v36
    v_mul_u32_u24 v37, 0x30000, v35
    v_lshl_add_u32 v37, v36, 4, v37
    v_add_u32 v37, v37, v29
    s_waitcnt lgkmcnt(0)
    v_pk_mul_f32 v[26:27], v[88:89], v[24:25] op_sel_hi:[1,0]
    v_pk_fma_f32 v[40:41], v[40:41], v[72:73], v[26:27] neg_lo:[0,0,1] neg_hi:[0,0,1]
    v_pk_mul_f32 v[26:27], v[90:91], v[24:25] op_sel_hi:[1,0]
    v_pk_fma_f32 v[42:43], v[42:43], v[74:75], v[26:27] neg_lo:[0,0,1] neg_hi:[0,0,1]
    v_pk_mul_f32 v[26:27], v[92:93], v[24:25] op_sel_hi:[1,0]
    v_pk_fma_f32 v[44:45], v[44:45], v[76:77], v[26:27] neg_lo:[0,0,1] neg_hi:[0,0,1]
    v_pk_mul_f32 v[26:27], v[94:95], v[24:25] op_sel_hi:[1,0]
    v_pk_fma_f32 v[46:47], v[46:47], v[78:79], v[26:27] neg_lo:[0,0,1] neg_hi:[0,0,1]
    v_pk_mul_f32 v[26:27], v[96:97], v[24:25] op_sel_hi:[1,0]
    v_pk_fma_f32 v[48:49], v[48:49], v[80:81], v[26:27] neg_lo:[0,0,1] neg_hi:[0,0,1]
    v_pk_mul_f32 v[26:27], v[98:99], v[24:25] op_sel_hi:[1,0]
    v_pk_fma_f32 v[50:51], v[50:51], v[82:83], v[26:27] neg_lo:[0,0,1] neg_hi:[0,0,1]
    v_pk_mul_f32 v[26:27], v[100:101], v[24:25] op_sel_hi:[1,0]
    v_pk_fma_f32 v[52:53], v[52:53], v[84:85], v[26:27] neg_lo:[0,0,1] neg_hi:[0,0,1]
    v_pk_mul_f32 v[26:27], v[102:103], v[24:25] op_sel_hi:[1,0]
    v_pk_fma_f32 v[54:55], v[54:55], v[86:87], v[26:27] neg_lo:[0,0,1] neg_hi:[0,0,1]
    v_cvt_pk_bf16_f32 v104, v40, v41
    v_cvt_pk_bf16_f32 v105, v42, v43
    v_cvt_pk_bf16_f32 v106, v44, v45
    v_cvt_pk_bf16_f32 v107, v46, v47
    v_cvt_pk_bf16_f32 v108, v48, v49
    v_cvt_pk_bf16_f32 v109, v50, v51
    v_cvt_pk_bf16_f32 v110, v52, v53
    v_cvt_pk_bf16_f32 v111, v54, v55
    buffer_store_dwordx4 v[104:107], v37, s[16:19], 0 offen sc1
    buffer_store_dwordx4 v[108:111], v37, s[16:19], 0 offen offset:768 sc1
    v_cmp_eq_u32 vcc, 0, v36
    v_mov_b32 v38, 0x3f803f80
    s_nop 0
    v_cndmask_b32 v112, 0, v38, vcc
    v_cndmask_b32 v113, 0, v38, vcc
    v_cndmask_b32 v114, 0, v38, vcc
    v_cndmask_b32 v115, 0, v38, vcc
    v_cmp_gt_u32 vcc, 4, v36
    s_and_saveexec_b64 s[54:55], vcc
    s_cbranch_execz L_qa_e20_nc0
    buffer_store_dwordx4 v[112:115], v37, s[16:19], 0 offen offset:320 sc1
    buffer_store_dwordx4 v[112:115], v37, s[16:19], 0 offen offset:1088 sc1
L_qa_e20_nc0:
    s_mov_b64 exec, s[54:55]
    s_nop 1
    s_lshl_b32 s37, s41, 7
    v_add_u32 v33, s37, v32
    ds_read_b32 v24, v33
    s_lshl_b32 s37, s35, 2
    s_lshl_b32 s39, s41, 5
    s_add_u32 s37, s37, s39
    v_add_u32 v34, s37, v3
    v_mul_u32_u24 v35, 3277, v34
    v_lshrrev_b32 v35, 16, v35
    v_mul_u32_u24 v36, 20, v35
    v_sub_u32 v36, v34, v36
    v_mul_u32_u24 v37, 0x30000, v35
    v_lshl_add_u32 v37, v36, 4, v37
    v_add_u32 v37, v37, v29
    s_waitcnt lgkmcnt(0)
    v_pk_mul_f32 v[26:27], v[88:89], v[24:25] op_sel_hi:[1,0]
    v_pk_fma_f32 v[56:57], v[56:57], v[72:73], v[26:27] neg_lo:[0,0,1] neg_hi:[0,0,1]
    v_pk_mul_f32 v[26:27], v[90:91], v[24:25] op_sel_hi:[1,0]
    v_pk_fma_f32 v[58:59], v[58:59], v[74:75], v[26:27] neg_lo:[0,0,1] neg_hi:[0,0,1]
    v_pk_mul_f32 v[26:27], v[92:93], v[24:25] op_sel_hi:[1,0]
    v_pk_fma_f32 v[60:61], v[60:61], v[76:77], v[26:27] neg_lo:[0,0,1] neg_hi:[0,0,1]
    v_pk_mul_f32 v[26:27], v[94:95], v[24:25] op_sel_hi:[1,0]
    v_pk_fma_f32 v[62:63], v[62:63], v[78:79], v[26:27] neg_lo:[0,0,1] neg_hi:[0,0,1]
    v_pk_mul_f32 v[26:27], v[96:97], v[24:25] op_sel_hi:[1,0]
    v_pk_fma_f32 v[64:65], v[64:65], v[80:81], v[26:27] neg_lo:[0,0,1] neg_hi:[0,0,1]
    v_pk_mul_f32 v[26:27], v[98:99], v[24:25] op_sel_hi:[1,0]
    v_pk_fma_f32 v[66:67], v[66:67], v[82:83], v[26:27] neg_lo:[0,0,1] neg_hi:[0,0,1]
    v_pk_mul_f32 v[26:27], v[100:101], v[24:25] op_sel_hi:[1,0]
    v_pk_fma_f32 v[68:69], v[68:69], v[84:85], v[26:27] neg_lo:[0,0,1] neg_hi:[0,0,1]
    v_pk_mul_f32 v[26:27], v[102:103], v[24:25] op_sel_hi:[1,0]
    v_pk_fma_f32 v[70:71], v[70:71], v[86:87], v[26:27] neg_lo:[0,0,1] neg_hi:[0,0,1]
    v_cvt_pk_bf16_f32 v104, v56, v57
    v_cvt_pk_bf16_f32 v105, v58, v59
    v_cvt_pk_bf16_f32 v106, v60, v61
    v_cvt_pk_bf16_f32 v107, v62, v63
    v_cvt_pk_bf16_f32 v108, v64, v65
    v_cvt_pk_bf16_f32 v109, v66, v67
    v_cvt_pk_bf16_f32 v110, v68, v69
    v_cvt_pk_bf16_f32 v111, v70, v71
    buffer_store_dwordx4 v[104:107], v37, s[16:19], 0 offen sc1
    buffer_store_dwordx4 v[108:111], v37, s[16:19], 0 offen offset:768 sc1
    v_cmp_eq_u32 vcc, 0, v36
    v_mov_b32 v38, 0x3f803f80
    s_nop 0
    v_cndmask_b32 v112, 0, v38, vcc
    v_cndmask_b32 v113, 0, v38, vcc
    v_cndmask_b32 v114, 0, v38, vcc
    v_cndmask_b32 v115, 0, v38, vcc
    v_cmp_gt_u32 vcc, 4, v36
    s_and_saveexec_b64 s[54:55], vcc
    s_cbranch_execz L_qa_e20_nc1
    buffer_store_dwordx4 v[112:115], v37, s[16:19], 0 offen offset:320 sc1
    buffer_store_dwordx4 v[112:115], v37, s[16:19], 0 offen offset:1088 sc1
L_qa_e20_nc1:
    s_mov_b64 exec, s[54:55]
    s_nop 1
    s_branch L_qa_pub
L_qa_nt2:
L_qa_pub:
    s_waitcnt vmcnt(0) lgkmcnt(0)
    s_barrier
    s_cmp_lg_u32 s23, 0
    s_cbranch_scc1 L_qa_nof
    s_memrealtime s[82:83]
    s_lshl_b32 s36, s21, 4
    s_add_u32 s36, s36, s20
    s_lshl_b32 s36, s36, 7
    s_add_u32 s36, s36, 21561344
    v_mov_b32 v10, s36
    s_waitcnt lgkmcnt(0)
    v_mov_b32 v12, s82
    v_xor_b32 v13, 0x5bd1e995, v12
    s_mov_b64 s[88:89], exec
    s_mov_b64 exec, 1
    global_store_dwordx2 v10, v[12:13], s[4:5] sc1
    s_mov_b64 exec, s[88:89]
L_qa_nof:
    s_setprio 0
L_k2_att:
    s_mov_b32 s93, 1
    s_and_b32 s20, s2, 7
    s_lshr_b32 s21, s2, 3
    s_and_b32 s22, s21, 3
    s_lshl_b32 s20, s20, 2
    s_add_u32 s20, s20, s22
    s_lshr_b32 s21, s21, 2
    s_mul_i32 s22, s20, 196608
    s_add_u32 s22, s22, 3145728
    s_add_u32 s8, s4, s22
    s_addc_u32 s9, s5, 0
    s_mov_b32 s10, 196608
    s_mov_b32 s11, 0x00020000
    s_mul_i32 s22, s20, 81920
    s_add_u32 s12, s4, s22
    s_addc_u32 s13, s5, 0
    s_mov_b32 s14, 81920
    s_mov_b32 s15, 0x00020000
    s_add_u32 s16, s4, 15728640
    s_addc_u32 s17, s5, 0
    s_mov_b32 s18, 2621440
    s_mov_b32 s19, 0x00020000
    v_lshrrev_b32 v1, 6, v0
    v_and_b32 v2, 63, v0
    s_nop 0
    v_readfirstlane_b32 s23, v1
    v_and_b32 v3, 31, v2
    v_lshrrev_b32 v1, 5, v2
    v_mov_b32 v106, 0
    s_mov_b64 s[46:47], 0
    s_cmp_lg_u32 s23, 0
    s_cbranch_scc1 L_aw_wd
    s_mov_b32 s94, 0
    s_mul_i32 s37, s20, 20
    s_lshr_b32 s28, s37, 7
    s_add_u32 s37, s37, 19
    s_lshr_b32 s29, s37, 7
    v_bfe_u32 v100, v2, 4, 1
    v_mov_b32 v101, s28
    v_mov_b32 v102, s29
    v_cmp_eq_u32 vcc, 1, v100
    s_nop 1
    v_cndmask_b32 v101, v101, v102, vcc
    v_lshrrev_b32 v102, 5, v2
    v_mul_u32_u24 v102, 5, v102
    v_add3_u32 v102, v102, v101, 5
    v_and_b32 v103, 15, v2
    v_lshl_add_u32 v104, v102, 4, v103
    v_and_b32 v103, 1, v2
    s_lshl_b32 s37, s21, 1
    v_add_u32 v103, s37, v103
    v_lshl_add_u32 v105, v101, 4, v103
    s_mov_b32 s37, 21561344
    v_lshl_add_u32 v106, v104, 7, s37
    v_lshl_add_u32 v107, v105, 7, s37
    s_mov_b32 s44, 0x000f000f
    s_mov_b32 s45, 0x000f000f
    s_cmp_lg_u32 s93, 0
    s_cselect_b32 s44, -1, s44
    s_cselect_b32 s45, -1, s45
    s_mov_b32 s38, 0
L_aw_poll:
    global_load_dwordx2 v[100:101], v106, s[4:5] sc1
    global_load_dwordx2 v[102:103], v107, s[4:5] sc1
    s_waitcnt vmcnt(0)
    v_subrev_u32 v108, s90, v100
    v_add_u32 v108, -1, v108
    v_xor_b32 v101, v101, v100
    v_xor_b32 v101, 0x5bd1e995, v101
    v_lshrrev_b32 v108, 24, v108
    v_or_b32 v108, v108, v101
    v_cmp_ne_u32 vcc, 0, v108
    v_subrev_u32 v108, s90, v102
    v_add_u32 v108, -1, v108
    v_xor_b32 v103, v103, v102
    v_xor_b32 v103, 0x5bd1e995, v103
    v_lshrrev_b32 v108, 24, v108
    v_or_b32 v108, v108, v103
    v_cmp_ne_u32 s[30:31], 0, v108
    s_nop 3
    s_mov_b64 s[46:47], vcc
    s_and_b64 vcc, vcc, s[44:45]
    s_or_b64 s[32:33], vcc, s[30:31]
    s_cmp_eq_u64 s[32:33], 0
    s_cbranch_scc1 L_aw_ok
    s_sleep 6
    s_add_u32 s38, s38, 1
    s_cmp_lt_u32 s38, 400
    s_cbranch_scc1 L_aw_poll
    s_cmp_eq_u64 vcc, 0
    s_cbranch_scc1 L_aw_mq
    s_ff1_i32_b64 s39, vcc
    s_nop 3
    v_readlane_b32 s94, v104, s39
    s_branch L_aw_m2
L_aw_mq:
    s_ff1_i32_b64 s39, s[30:31]
    s_nop 3
    v_readlane_b32 s94, v105, s39
L_aw_m2:
    s_nop 3
    s_add_u32 s94, s94, 1
L_aw_ok:
    v_mov_b32 v100, 81912
    v_mov_b32 v101, s94
    ds_write_b32 v100, v101
L_aw_wd:
    s_waitcnt vmcnt(0) lgkmcnt(0)
    s_barrier
    v_mov_b32 v100, 81912
    ds_read_b32 v101, v100
    s_waitcnt lgkmcnt(0)
    v_readfirstlane_b32 s94, v101
    s_nop 3
    s_cmp_eq_u32 s94, 0
    s_cbranch_scc1 L_aw_go
    s_barrier
    s_sub_u32 s94, s94, 1
    s_and_b32 s20, s94, 15
    s_lshr_b32 s21, s94, 4
    s_branch L_qkv_task
L_aw_go:
    s_mul_i32 s29, s23, 3072
    v_lshl_add_u32 v119, v2, 4, s29
    s_mov_b32 m0, s29
    s_mov_b32 s27, 0
    buffer_load_dwordx4 v119, s[8:11], s27 offen lds
    buffer_load_dwordx4 v119, s[8:11], s27 offen offset:1024 lds
    buffer_load_dwordx4 v119, s[8:11], s27 offen offset:2048 lds
    s_and_b32 s39, s23, 3
    s_lshr_b32 s40, s23, 2
    s_lshl_b32 s30, s21, 8
    s_lshl_b32 s31, s39, 6
    s_add_u32 s30, s30, s31
    v_add_u32 v76, s30, v3
    v_lshlrev_b32 v77, 3, v76
    v_lshl_add_u32 v78, v1, 14, v77
    s_mov_b32 s31, 32768
    s_mov_b32 s35, 65536
    buffer_load_dwordx2 v[4:5], v78, s[12:15], 0 offen
    buffer_load_dwordx2 v[6:7], v78, s[12:15], s31 offen
    buffer_load_dwordx2 v[8:9], v77, s[12:15], s35 offen
    buffer_load_dwordx2 v[10:11], v78, s[12:15], 0 offen offset:256
    buffer_load_dwordx2 v[12:13], v78, s[12:15], s31 offen offset:256
    buffer_load_dwordx2 v[14:15], v77, s[12:15], s35 offen offset:256
    s_add_u32 s26, s29, 24576
    s_mov_b32 m0, s26
    s_mov_b32 s27, 24576
    buffer_load_dwordx4 v119, s[8:11], s27 offen lds
    buffer_load_dwordx4 v119, s[8:11], s27 offen offset:1024 lds
    buffer_load_dwordx4 v119, s[8:11], s27 offen offset:2048 lds
    v_lshlrev_b32 v116, 3, v3
    v_lshl_add_u32 v116, v1, 8, v116
    v_add_u32 v117, 1024, v116
    v_min_u32 v118, 23, v3
    v_lshlrev_b32 v118, 4, v118
    v_mul_u32_u24 v79, 384, v1
    v_add_u32 v118, v118, v79
    v_add_u32 v118, 1536, v118
    s_mul_i32 s31, s20, 81920
    s_lshl_b32 s35, s40, 8
    s_add_u32 s31, s31, s35
    v_add_u32 v2, s31, v78
    v_mov_b32 v84, 0
    v_mov_b32 v85, 0
    v_mov_b32 v86, 0
    v_mov_b32 v87, 0
    v_mov_b32 v88, 0
    v_mov_b32 v89, 0
    v_mov_b32 v90, 0
    v_mov_b32 v91, 0
    v_mov_b32 v92, 0
    v_mov_b32 v93, 0
    v_mov_b32 v94, 0
    v_mov_b32 v95, 0
    v_mov_b32 v96, 0
    v_mov_b32 v97, 0
    v_mov_b32 v98, 0
    v_mov_b32 v99, 0
    v_mov_b32 v100, 0
    v_mov_b32 v101, 0
    v_mov_b32 v102, 0
    v_mov_b32 v103, 0
    v_mov_b32 v104, 0
    v_mov_b32 v105, 0
    v_mov_b32 v106, 0
    v_mov_b32 v107, 0
    v_mov_b32 v108, 0
    v_mov_b32 v109, 0
    v_mov_b32 v110, 0
    v_mov_b32 v111, 0
    v_mov_b32 v112, 0
    v_mov_b32 v113, 0
    v_mov_b32 v114, 0
    v_mov_b32 v115, 0
    s_mov_b32 s32, 0
    s_mov_b32 s33, -1
    s_waitcnt vmcnt(3)
    v_cndmask_b32 v8, v8, 0, s[32:33]
    v_cndmask_b32 v9, v9, 0, s[32:33]
    v_cndmask_b32 v14, v14, 0, s[32:33]
    v_cndmask_b32 v15, v15, 0, s[32:33]
    s_barrier
    ds_read2st64_b64 v[22:25], v116 offset0:0 offset1:1
    ds_read_b64 v[26:27], v117
    s_mul_i32 s35, s40, 12288
    v_add_u32 v116, s35, v116
    v_add_u32 v117, s35, v117
    v_add_u32 v118, s35, v118
    ds_read2st64_b64 v[16:19], v116 offset0:0 offset1:1
    ds_read_b64 v[20:21], v117
    ds_read_b128 v[28:31], v118
    ds_read_b128 v[32:35], v118 offset:768
    s_waitcnt lgkmcnt(4)
    v_mfma_f32_32x32x8_bf16 v[44:59], v[26:27], v[8:9], 0
    v_mfma_f32_32x32x8_bf16 v[60:75], v[26:27], v[14:15], 0
    v_mfma_f32_32x32x16_bf16 v[44:59], v[22:25], v[4:7], v[44:59]
    v_mfma_f32_32x32x16_bf16 v[60:75], v[22:25], v[10:13], v[60:75]
    s_nop 15
    v_max3_f32 v76, v44, v45, v46
    v_max3_f32 v76, v76, v47, v48
    v_max3_f32 v76, v76, v49, v50
    v_max3_f32 v76, v76, v51, v52
    v_max3_f32 v76, v76, v53, v54
    v_max3_f32 v76, v76, v55, v56
    v_max3_f32 v76, v76, v57, v58
    v_max_f32 v76, v76, v59
    v_mov_b32 v77, v76
    v_mov_b32 v78, v76
    s_nop 1
    v_permlane32_swap_b32 v77, v78
    s_nop 1
    v_max_f32 v76, v77, v78
    v_sub_f32 v76, 0, v76
    v_cvt_pk_bf16_f32 v76, v76, 0
    s_nop 0
    v_cndmask_b32 v8, v8, v76, s[32:33]
    v_max3_f32 v76, v60, v61, v62
    v_max3_f32 v76, v76, v63, v64
    v_max3_f32 v76, v76, v65, v66
    v_max3_f32 v76, v76, v67, v68
    v_max3_f32 v76, v76, v69, v70
    v_max3_f32 v76, v76, v71, v72
    v_max3_f32 v76, v76, v73, v74
    v_max_f32 v76, v76, v75
    v_mov_b32 v77, v76
    v_mov_b32 v78, v76
    s_nop 1
    v_permlane32_swap_b32 v77, v78
    s_nop 1
    v_max_f32 v76, v77, v78
    v_sub_f32 v76, 0, v76
    v_cvt_pk_bf16_f32 v76, v76, 0
    s_nop 0
    v_cndmask_b32 v14, v14, v76, s[32:33]
    s_waitcnt lgkmcnt(0)
    s_nop 1
    v_mfma_f32_32x32x8_bf16 v[44:59], v[20:21], v[8:9], 0
    v_mfma_f32_32x32x16_bf16 v[44:59], v[16:19], v[4:7], v[44:59]
    v_mov_b32 v80, 0
    v_mov_b32 v81, 0
    v_mov_b32 v82, 0
    v_mov_b32 v83, 0
    v_mov_b32 v40, 0
    v_mov_b32 v41, 0
    v_mov_b32 v42, 0
    v_mov_b32 v43, 0
    s_mov_b32 s24, 0
    s_mov_b32 s25, 0
    s_add_u32 s26, s29, 49152
    s_mov_b32 s34, 0
    s_mov_b32 s42, -49152
    s_mov_b32 s43, 24576
    s_nop 7
L_att_loop:
    s_cmp_eq_u32 s34, 2
    s_cselect_b32 s28, s42, s43
    s_waitcnt lgkmcnt(0)
    ds_read2st64_b64 v[22:25], v116 offset0:6 offset1:7
    ds_read_b64 v[26:27], v117 offset:3072
    v_mfma_f32_32x32x16_bf16 v[100:115], v[40:43], v[80:83], v[100:115]
    v_exp_f32 v44, v44
    v_exp_f32 v45, v45
    v_exp_f32 v46, v46
    v_exp_f32 v47, v47
    v_mfma_f32_32x32x8_bf16 v[60:75], v[20:21], v[14:15], 0
    v_exp_f32 v48, v48
    v_exp_f32 v49, v49
    v_exp_f32 v50, v50
    v_exp_f32 v51, v51
    v_mfma_f32_32x32x16_bf16 v[60:75], v[16:19], v[10:13], v[60:75]
    v_cvt_pk_bf16_f32 v76, v44, v45
    v_cvt_pk_bf16_f32 v77, v46, v47
    v_cvt_pk_bf16_f32 v78, v48, v49
    v_cvt_pk_bf16_f32 v79, v50, v51
    v_exp_f32 v52, v52
    v_exp_f32 v53, v53
    v_mfma_f32_32x32x16_bf16 v[84:99], v[28:31], v[76:79], v[84:99]
    v_exp_f32 v54, v54
    v_exp_f32 v55, v55
    v_exp_f32 v56, v56
    v_exp_f32 v57, v57
    v_exp_f32 v58, v58
    v_exp_f32 v59, v59
    v_cvt_pk_bf16_f32 v80, v52, v53
    v_cvt_pk_bf16_f32 v81, v54, v55
    v_cvt_pk_bf16_f32 v82, v56, v57
    v_cvt_pk_bf16_f32 v83, v58, v59
    s_waitcnt lgkmcnt(0)
    s_nop 1
    v_mfma_f32_32x32x16_bf16 v[84:99], v[32:35], v[80:83], v[84:99]
    v_exp_f32 v60, v60
    v_exp_f32 v61, v61
    v_exp_f32 v62, v62
    v_exp_f32 v63, v63
    v_mfma_f32_32x32x8_bf16 v[44:59], v[26:27], v[8:9], 0
    v_exp_f32 v64, v64
    v_exp_f32 v65, v65
    v_exp_f32 v66, v66
    v_exp_f32 v67, v67
    ds_read_b128 v[36:39], v118 offset:3072
    ds_read_b128 v[40:43], v118 offset:3840
    v_mfma_f32_32x32x16_bf16 v[44:59], v[22:25], v[4:7], v[44:59]
    v_cvt_pk_bf16_f32 v76, v60, v61
    v_cvt_pk_bf16_f32 v77, v62, v63
    v_cvt_pk_bf16_f32 v78, v64, v65
    v_cvt_pk_bf16_f32 v79, v66, v67
    v_exp_f32 v68, v68
    v_exp_f32 v69, v69
    v_mfma_f32_32x32x16_bf16 v[100:115], v[28:31], v[76:79], v[100:115]
    v_exp_f32 v70, v70
    v_exp_f32 v71, v71
    v_exp_f32 v72, v72
    v_exp_f32 v73, v73
    v_exp_f32 v74, v74
    v_exp_f32 v75, v75
    v_cvt_pk_bf16_f32 v80, v68, v69
    v_cvt_pk_bf16_f32 v81, v70, v71
    v_cvt_pk_bf16_f32 v82, v72, v73
    v_cvt_pk_bf16_f32 v83, v74, v75
    s_waitcnt lgkmcnt(0)
    ds_read2st64_b64 v[16:19], v116 offset0:12 offset1:13
    ds_read_b64 v[20:21], v117 offset:6144
    v_mfma_f32_32x32x16_bf16 v[100:115], v[32:35], v[80:83], v[100:115]
    v_exp_f32 v44, v44
    v_exp_f32 v45, v45
    v_exp_f32 v46, v46
    v_exp_f32 v47, v47
    v_mfma_f32_32x32x8_bf16 v[60:75], v[26:27], v[14:15], 0
    v_exp_f32 v48, v48
    v_exp_f32 v49, v49
    v_exp_f32 v50, v50
    v_exp_f32 v51, v51
    v_mfma_f32_32x32x16_bf16 v[60:75], v[22:25], v[10:13], v[60:75]
    v_cvt_pk_bf16_f32 v76, v44, v45
    v_cvt_pk_bf16_f32 v77, v46, v47
    v_cvt_pk_bf16_f32 v78, v48, v49
    v_cvt_pk_bf16_f32 v79, v50, v51
    v_exp_f32 v52, v52
    v_exp_f32 v53, v53
    v_mfma_f32_32x32x16_bf16 v[84:99], v[36:39], v[76:79], v[84:99]
    v_exp_f32 v54, v54
    v_exp_f32 v55, v55
    v_exp_f32 v56, v56
    v_exp_f32 v57, v57
    v_exp_f32 v58, v58
    v_exp_f32 v59, v59
    v_cvt_pk_bf16_f32 v80, v52, v53
    v_cvt_pk_bf16_f32 v81, v54, v55
    v_cvt_pk_bf16_f32 v82, v56, v57
    v_cvt_pk_bf16_f32 v83, v58, v59
    s_waitcnt lgkmcnt(0)
    s_nop 1
    v_mfma_f32_32x32x16_bf16 v[84:99], v[40:43], v[80:83], v[84:99]
    v_exp_f32 v60, v60
    v_exp_f32 v61, v61
    v_exp_f32 v62, v62
    v_exp_f32 v63, v63
    v_mfma_f32_32x32x8_bf16 v[44:59], v[20:21], v[8:9], 0
    v_exp_f32 v64, v64
    v_exp_f32 v65, v65
    v_exp_f32 v66, v66
    v_exp_f32 v67, v67
    ds_read_b128 v[28:31], v118 offset:6144
    ds_read_b128 v[32:35], v118 offset:6912
    v_mfma_f32_32x32x16_bf16 v[44:59], v[16:19], v[4:7], v[44:59]
    v_cvt_pk_bf16_f32 v76, v60, v61
    v_cvt_pk_bf16_f32 v77, v62, v63
    v_cvt_pk_bf16_f32 v78, v64, v65
    v_cvt_pk_bf16_f32 v79, v66, v67
    v_exp_f32 v68, v68
    v_exp_f32 v69, v69
    v_mfma_f32_32x32x16_bf16 v[100:115], v[36:39], v[76:79], v[100:115]
    v_exp_f32 v70, v70
    v_exp_f32 v71, v71
    v_exp_f32 v72, v72
    v_exp_f32 v73, v73
    v_exp_f32 v74, v74
    v_exp_f32 v75, v75
    v_cvt_pk_bf16_f32 v80, v68, v69
    v_cvt_pk_bf16_f32 v81, v70, v71
    v_cvt_pk_bf16_f32 v82, v72, v73
    v_cvt_pk_bf16_f32 v83, v74, v75
    s_waitcnt lgkmcnt(0)
    ds_read2st64_b64 v[22:25], v116 offset0:18 offset1:19
    ds_read_b64 v[26:27], v117 offset:9216
    v_mfma_f32_32x32x16_bf16 v[100:115], v[40:43], v[80:83], v[100:115]
    v_exp_f32 v44, v44
    v_exp_f32 v45, v45
    v_exp_f32 v46, v46
    v_exp_f32 v47, v47
    v_mfma_f32_32x32x8_bf16 v[60:75], v[20:21], v[14:15], 0
    v_exp_f32 v48, v48
    v_exp_f32 v49, v49
    v_exp_f32 v50, v50
    v_exp_f32 v51, v51
    v_mfma_f32_32x32x16_bf16 v[60:75], v[16:19], v[10:13], v[60:75]
    v_cvt_pk_bf16_f32 v76, v44, v45
    v_cvt_pk_bf16_f32 v77, v46, v47
    v_cvt_pk_bf16_f32 v78, v48, v49
    v_cvt_pk_bf16_f32 v79, v50, v51
    v_exp_f32 v52, v52
    v_exp_f32 v53, v53
    v_mfma_f32_32x32x16_bf16 v[84:99], v[28:31], v[76:79], v[84:99]
    v_exp_f32 v54, v54
    v_exp_f32 v55, v55
    v_exp_f32 v56, v56
    v_exp_f32 v57, v57
    v_exp_f32 v58, v58
    v_exp_f32 v59, v59
    v_cvt_pk_bf16_f32 v80, v52, v53
    v_cvt_pk_bf16_f32 v81, v54, v55
    v_cvt_pk_bf16_f32 v82, v56, v57
    v_cvt_pk_bf16_f32 v83, v58, v59
    s_waitcnt lgkmcnt(0)
    s_nop 1
    v_mfma_f32_32x32x16_bf16 v[84:99], v[32:35], v[80:83], v[84:99]
    v_exp_f32 v60, v60
    v_exp_f32 v61, v61
    v_exp_f32 v62, v62
    v_exp_f32 v63, v63
    v_mfma_f32_32x32x8_bf16 v[44:59], v[26:27], v[8:9], 0
    v_exp_f32 v64, v64
    v_exp_f32 v65, v65
    v_exp_f32 v66, v66
    v_exp_f32 v67, v67
    ds_read_b128 v[36:39], v118 offset:9216
    ds_read_b128 v[40:43], v118 offset:9984
    v_mfma_f32_32x32x16_bf16 v[44:59], v[22:25], v[4:7], v[44:59]
    v_cvt_pk_bf16_f32 v76, v60, v61
    v_cvt_pk_bf16_f32 v77, v62, v63
    v_cvt_pk_bf16_f32 v78, v64, v65
    v_cvt_pk_bf16_f32 v79, v66, v67
    v_exp_f32 v68, v68
    v_exp_f32 v69, v69
    v_mfma_f32_32x32x16_bf16 v[100:115], v[28:31], v[76:79], v[100:115]
    v_exp_f32 v70, v70
    v_exp_f32 v71, v71
    v_exp_f32 v72, v72
    v_exp_f32 v73, v73
    v_exp_f32 v74, v74
    v_exp_f32 v75, v75
    v_cvt_pk_bf16_f32 v80, v68, v69
    v_cvt_pk_bf16_f32 v81, v70, v71
    v_cvt_pk_bf16_f32 v82, v72, v73
    v_cvt_pk_bf16_f32 v83, v74, v75
    s_waitcnt lgkmcnt(0)
    s_waitcnt vmcnt(0)
    s_barrier
    s_cmp_ge_u32 s24, 6
    s_cbranch_scc1 L_att_nodma
    s_mov_b32 m0, s26
    s_add_u32 s27, s25, 49152
    buffer_load_dwordx4 v119, s[8:11], s27 offen lds
    buffer_load_dwordx4 v119, s[8:11], s27 offen offset:1024 lds
    buffer_load_dwordx4 v119, s[8:11], s27 offen offset:2048 lds
L_att_nodma:
    v_add_u32 v116, s28, v116
    v_add_u32 v117, s28, v117
    ds_read2st64_b64 v[16:19], v116 offset0:0 offset1:1
    ds_read_b64 v[20:21], v117 offset:0
    v_mfma_f32_32x32x16_bf16 v[100:115], v[32:35], v[80:83], v[100:115]
    v_exp_f32 v44, v44
    v_exp_f32 v45, v45
    v_exp_f32 v46, v46
    v_exp_f32 v47, v47
    v_mfma_f32_32x32x8_bf16 v[60:75], v[26:27], v[14:15], 0
    v_exp_f32 v48, v48
    v_exp_f32 v49, v49
    v_exp_f32 v50, v50
    v_exp_f32 v51, v51
    v_mfma_f32_32x32x16_bf16 v[60:75], v[22:25], v[10:13], v[60:75]
    v_cvt_pk_bf16_f32 v76, v44, v45
    v_cvt_pk_bf16_f32 v77, v46, v47
    v_cvt_pk_bf16_f32 v78, v48, v49
    v_cvt_pk_bf16_f32 v79, v50, v51
    v_exp_f32 v52, v52
    v_exp_f32 v53, v53
    v_mfma_f32_32x32x16_bf16 v[84:99], v[36:39], v[76:79], v[84:99]
    v_exp_f32 v54, v54
    v_exp_f32 v55, v55
    v_exp_f32 v56, v56
    v_exp_f32 v57, v57
    v_exp_f32 v58, v58
    v_exp_f32 v59, v59
    v_cvt_pk_bf16_f32 v80, v52, v53
    v_cvt_pk_bf16_f32 v81, v54, v55
    v_cvt_pk_bf16_f32 v82, v56, v57
    v_cvt_pk_bf16_f32 v83, v58, v59
    s_waitcnt lgkmcnt(0)
    v_add_u32 v118, s28, v118
    s_nop 1
    v_mfma_f32_32x32x16_bf16 v[84:99], v[40:43], v[80:83], v[84:99]
    v_exp_f32 v60, v60
    v_exp_f32 v61, v61
    v_exp_f32 v62, v62
    v_exp_f32 v63, v63
    v_mfma_f32_32x32x8_bf16 v[44:59], v[20:21], v[8:9], 0
    v_exp_f32 v64, v64
    v_exp_f32 v65, v65
    v_exp_f32 v66, v66
    v_exp_f32 v67, v67
    ds_read_b128 v[28:31], v118 offset:0
    ds_read_b128 v[32:35], v118 offset:768
    v_mfma_f32_32x32x16_bf16 v[44:59], v[16:19], v[4:7], v[44:59]
    v_cvt_pk_bf16_f32 v76, v60, v61
    v_cvt_pk_bf16_f32 v77, v62, v63
    v_cvt_pk_bf16_f32 v78, v64, v65
    v_cvt_pk_bf16_f32 v79, v66, v67
    v_exp_f32 v68, v68
    v_exp_f32 v69, v69
    v_mfma_f32_32x32x16_bf16 v[100:115], v[36:39], v[76:79], v[100:115]
    v_exp_f32 v70, v70
    v_exp_f32 v71, v71
    v_exp_f32 v72, v72
    v_exp_f32 v73, v73
    v_exp_f32 v74, v74
    v_exp_f32 v75, v75
    v_cvt_pk_bf16_f32 v80, v68, v69
    v_cvt_pk_bf16_f32 v81, v70, v71
    v_cvt_pk_bf16_f32 v82, v72, v73
    v_cvt_pk_bf16_f32 v83, v74, v75
    s_add_u32 s34, s34, 1
    s_cmp_eq_u32 s34, 3
    s_cselect_b32 s34, 0, s34
    s_add_u32 s35, s34, 2
    s_cmp_ge_u32 s35, 3
    s_cselect_b32 s36, 3, 0
    s_sub_u32 s35, s35, s36
    s_mul_i32 s35, s35, 24576
    s_add_u32 s26, s35, s29
    s_add_u32 s25, s25, 24576
    s_add_u32 s24, s24, 1
    s_cmp_lt_u32 s24, 8
    s_cbranch_scc1 L_att_loop
    s_nop 1
    v_mfma_f32_32x32x16_bf16 v[100:115], v[40:43], v[80:83], v[100:115]
    s_waitcnt lgkmcnt(0)
    s_barrier
    v_and_b32 v3, 63, v0
    s_lshl_b32 s35, s23, 12
    v_lshl_add_u32 v76, v3, 4, s35
    s_xor_b32 s36, s23, 4
    s_lshl_b32 s36, s36, 12
    v_lshl_add_u32 v77, v3, 4, s36
    s_nop 7
    s_cmp_eq_u32 s40, 0
    s_cbranch_scc0 L_att_x1
    ds_write_b128 v76, v[100:103] offset:0
    ds_write_b128 v76, v[104:107] offset:1024
    ds_write_b128 v76, v[108:111] offset:2048
    s_branch L_att_x2
L_att_x1:
    ds_write_b128 v76, v[84:87] offset:0
    ds_write_b128 v76, v[88:91] offset:1024
    ds_write_b128 v76, v[92:95] offset:2048
    s_waitcnt lgkmcnt(0)
    v_mov_b32 v84, v100
    v_mov_b32 v85, v101
    v_mov_b32 v86, v102
    v_mov_b32 v87, v103
    v_mov_b32 v88, v104
    v_mov_b32 v89, v105
    v_mov_b32 v90, v106
    v_mov_b32 v91, v107
    v_mov_b32 v92, v108
    v_mov_b32 v93, v109
    v_mov_b32 v94, v110
    v_mov_b32 v95, v111
    v_mov_b32 v4, v10
    v_mov_b32 v5, v11
    v_mov_b32 v6, v12
    v_mov_b32 v7, v13
    v_mov_b32 v8, v14
    v_mov_b32 v9, v15
L_att_x2:
    s_waitcnt lgkmcnt(0)
    s_barrier
    ds_read_b128 v[44:47], v77 offset:0
    ds_read_b128 v[48:51], v77 offset:1024
    ds_read_b128 v[52:55], v77 offset:2048
    s_waitcnt lgkmcnt(0)
    v_add_f32 v84, v84, v44
    v_add_f32 v85, v85, v45
    v_add_f32 v86, v86, v46
    v_add_f32 v87, v87, v47
    v_add_f32 v88, v88, v48
    v_add_f32 v89, v89, v49
    v_add_f32 v90, v90, v50
    v_add_f32 v91, v91, v51
    v_add_f32 v92, v92, v52
    v_add_f32 v93, v93, v53
    v_add_f32 v94, v94, v54
    v_add_f32 v95, v95, v55
    v_mov_b32 v76, v92
    v_mov_b32 v77, v92
    s_nop 1
    v_permlane32_swap_b32 v76, v77
    s_nop 1
    s_mov_b32 s36, 0x1f800000
    s_mov_b32 s37, 0x5f800000
    v_cmp_lt_f32 vcc, s36, v77
    v_cmp_gt_f32 s[38:39], s37, v77
    s_nop 3
    s_and_b64 s[38:39], s[38:39], vcc
    s_cmp_eq_u64 s[38:39], -1
    s_cbranch_scc1 L_att_fin
    v_and_b32 v3, 31, v0
    v_bfe_u32 v1, v0, 5, 1
    v_lshlrev_b32 v116, 3, v3
    v_lshl_add_u32 v116, v1, 8, v116
    v_add_u32 v117, 1024, v116
    v_min_u32 v118, 23, v3
    v_lshlrev_b32 v118, 4, v118
    v_mul_u32_u24 v100, 384, v1
    v_add_u32 v118, v118, v100
    v_add_u32 v118, 1536, v118
    v_cndmask_b32 v8, v8, 0, s[32:33]
    v_mov_b32 v84, 0
    v_mov_b32 v85, 0
    v_mov_b32 v86, 0
    v_mov_b32 v87, 0
    v_mov_b32 v88, 0
    v_mov_b32 v89, 0
    v_mov_b32 v90, 0
    v_mov_b32 v91, 0
    v_mov_b32 v92, 0
    v_mov_b32 v93, 0
    v_mov_b32 v94, 0
    v_mov_b32 v95, 0
    v_mov_b32 v96, 0
    v_mov_b32 v97, 0
    v_mov_b32 v98, 0
    v_mov_b32 v99, 0
    v_mov_b32 v108, 0xff800000
    s_mov_b32 s25, 0
L_att_slow:
    buffer_load_dwordx2 v[16:17], v116, s[8:11], s25 offen
    buffer_load_dwordx2 v[18:19], v116, s[8:11], s25 offen offset:512
    buffer_load_dwordx2 v[20:21], v117, s[8:11], s25 offen
    buffer_load_dwordx4 v[28:31], v118, s[8:11], s25 offen
    buffer_load_dwordx4 v[32:35], v118, s[8:11], s25 offen offset:768
    s_waitcnt vmcnt(0)
    v_mfma_f32_32x32x8_bf16 v[44:59], v[20:21], v[8:9], 0
    v_mfma_f32_32x32x16_bf16 v[44:59], v[16:19], v[4:7], v[44:59]
    s_nop 15
    v_max3_f32 v100, v44, v45, v46
    v_max3_f32 v100, v100, v47, v48
    v_max3_f32 v100, v100, v49, v50
    v_max3_f32 v100, v100, v51, v52
    v_max3_f32 v100, v100, v53, v54
    v_max3_f32 v100, v100, v55, v56
    v_max3_f32 v100, v100, v57, v58
    v_max_f32 v100, v100, v59
    v_mov_b32 v101, v100
    v_mov_b32 v102, v100
    s_nop 1
    v_permlane32_swap_b32 v101, v102
    s_nop 1
    v_max3_f32 v100, v101, v102, v108
    v_sub_f32 v109, v108, v100
    v_exp_f32 v109, v109
    v_mov_b32 v108, v100
    v_sub_f32 v44, v44, v108
    v_sub_f32 v45, v45, v108
    v_sub_f32 v46, v46, v108
    v_sub_f32 v47, v47, v108
    v_sub_f32 v48, v48, v108
    v_sub_f32 v49, v49, v108
    v_sub_f32 v50, v50, v108
    v_sub_f32 v51, v51, v108
    v_sub_f32 v52, v52, v108
    v_sub_f32 v53, v53, v108
    v_sub_f32 v54, v54, v108
    v_sub_f32 v55, v55, v108
    v_sub_f32 v56, v56, v108
    v_sub_f32 v57, v57, v108
    v_sub_f32 v58, v58, v108
    v_sub_f32 v59, v59, v108
    v_exp_f32 v44, v44
    v_exp_f32 v45, v45
    v_exp_f32 v46, v46
    v_exp_f32 v47, v47
    v_exp_f32 v48, v48
    v_exp_f32 v49, v49
    v_exp_f32 v50, v50
    v_exp_f32 v51, v51
    v_exp_f32 v52, v52
    v_exp_f32 v53, v53
    v_exp_f32 v54, v54
    v_exp_f32 v55, v55
    v_exp_f32 v56, v56
    v_exp_f32 v57, v57
    v_exp_f32 v58, v58
    v_exp_f32 v59, v59
    v_mul_f32 v84, v84, v109
    v_mul_f32 v85, v85, v109
    v_mul_f32 v86, v86, v109
    v_mul_f32 v87, v87, v109
    v_mul_f32 v88, v88, v109
    v_mul_f32 v89, v89, v109
    v_mul_f32 v90, v90, v109
    v_mul_f32 v91, v91, v109
    v_mul_f32 v92, v92, v109
    v_mul_f32 v93, v93, v109
    v_mul_f32 v94, v94, v109
    v_mul_f32 v95, v95, v109
    v_mul_f32 v96, v96, v109
    v_mul_f32 v97, v97, v109
    v_mul_f32 v98, v98, v109
    v_mul_f32 v99, v99, v109
    v_cvt_pk_bf16_f32 v76, v44, v45
    v_cvt_pk_bf16_f32 v77, v46, v47
    v_cvt_pk_bf16_f32 v78, v48, v49
    v_cvt_pk_bf16_f32 v79, v50, v51
    v_cvt_pk_bf16_f32 v80, v52, v53
    v_cvt_pk_bf16_f32 v81, v54, v55
    v_cvt_pk_bf16_f32 v82, v56, v57
    v_cvt_pk_bf16_f32 v83, v58, v59
    s_nop 1
    v_mfma_f32_32x32x16_bf16 v[84:99], v[28:31], v[76:79], v[84:99]
    v_mfma_f32_32x32x16_bf16 v[84:99], v[32:35], v[80:83], v[84:99]
    s_nop 15
    s_nop 3
    s_add_u32 s25, s25, 3072
    s_cmp_lt_u32 s25, 196608
    s_cbranch_scc1 L_att_slow
    v_mov_b32 v76, v92
    v_mov_b32 v77, v92
    s_nop 1
    v_permlane32_swap_b32 v76, v77
    s_nop 1
L_att_fin:
    v_rcp_f32 v60, v77
    s_nop 0
    v_mul_f32 v84, v84, v60
    v_mul_f32 v85, v85, v60
    v_mul_f32 v86, v86, v60
    v_mul_f32 v87, v87, v60
    v_mul_f32 v88, v88, v60
    v_mul_f32 v89, v89, v60
    v_mul_f32 v90, v90, v60
    v_mul_f32 v91, v91, v60
    v_mul_f32 v92, v92, v60
    v_mul_f32 v93, v93, v60
    v_mul_f32 v94, v94, v60
    v_mul_f32 v95, v95, v60
    v_cvt_pk_bf16_f32 v76, v84, v85
    v_cvt_pk_bf16_f32 v77, v86, v87
    v_cvt_pk_bf16_f32 v78, v88, v89
    v_cvt_pk_bf16_f32 v79, v90, v91
    v_cvt_pk_bf16_f32 v80, v92, v93
    v_cvt_pk_bf16_f32 v81, v94, v95
    s_mov_b32 s36, 32768
    s_mov_b32 s37, 65536
    buffer_store_dwordx2 v[76:77], v2, s[16:19], 0 offen sc1
    buffer_store_dwordx2 v[78:79], v2, s[16:19], s36 offen sc1
    s_mov_b64 s[40:41], exec
    s_mov_b32 exec_hi, 0
    buffer_store_dwordx2 v[80:81], v2, s[16:19], s37 offen sc1
    s_mov_b64 exec, s[40:41]
    s_waitcnt vmcnt(0) lgkmcnt(0)
    s_barrier
    s_cmp_lg_u32 s23, 0
    s_cbranch_scc1 L_att_nof
    s_memrealtime s[82:83]
    s_lshl_b32 s36, s21, 5
    s_add_u32 s36, s36, s20
    s_lshl_b32 s36, s36, 7
    s_add_u32 s36, s36, 21495808
    v_mov_b32 v10, s36
    s_waitcnt lgkmcnt(0)
    v_mov_b32 v12, s82
    v_xor_b32 v13, 0x5bd1e995, v12
    s_mov_b64 s[88:89], exec
    s_mov_b64 exec, 1
    global_store_dwordx2 v10, v[12:13], s[4:5] sc1
    s_mov_b64 exec, s[88:89]
L_att_nof:
    s_cmp_lg_u32 s97, 0
    s_cbranch_scc1 L_mb_resume
    s_branch L_kf_fin
L_pg_bail:
    s_waitcnt vmcnt(0) lgkmcnt(0)
    s_barrier
    s_mov_b32 s93, 1
    s_branch L_k2_att
L_k2_mlp:
    s_sub_u32 s3, s2, 256
    s_setprio 1
    s_load_dwordx4 s[56:59], s[0:1], 0
    s_load_dwordx2 s[60:61], s[0:1], 16
    s_load_dwordx2 s[62:63], s[0:1], 32
    s_load_dwordx2 s[64:65], s[0:1], 48
    s_lshl_b32 s37, s3, 13
    v_lshl_add_u32 v4, v0, 4, s37
    s_mov_b32 s38, 0x200000
    s_waitcnt lgkmcnt(0)
    s_add_u32 s8, s56, 0
    s_addc_u32 s9, s57, 0
    s_mov_b32 s10, 2621440
    s_mov_b32 s11, 0x00020000
    buffer_load_dwordx4 v[72:75], v4, s[8:11], 0 offen
    buffer_load_dwordx4 v[76:79], v4, s[8:11], s38 offen
    s_add_u32 s8, s58, 0
    s_addc_u32 s9, s59, 0
    s_mov_b32 s10, 2457600
    s_mov_b32 s11, 0x00020000
    buffer_load_dwordx4 v[80:83], v4, s[8:11], 0 offen
    buffer_load_dwordx4 v[84:87], v4, s[8:11], s38 offen
    s_add_u32 s8, s62, 0
    s_addc_u32 s9, s63, 0
    s_mov_b32 s10, 1966080
    s_mov_b32 s11, 0x00020000
    buffer_load_dwordx4 v[88:91], v4, s[8:11], 0 offen
    s_add_u32 s8, s64, 0
    s_addc_u32 s9, s65, 0
    s_mov_b32 s10, 1966080
    s_mov_b32 s11, 0x00020000
    buffer_load_dwordx4 v[92:95], v4, s[8:11], 0 offen
    s_add_u32 s8, s60, 0
    s_addc_u32 s9, s61, 0
    s_mov_b32 s10, 819200
    s_mov_b32 s11, 0x00020000
    buffer_load_dwordx4 v[96:99], v4, s[8:11], 0 offen
    s_and_b32 s37, s3, 7
    s_lshr_b32 s38, s3, 3
    s_and_b32 s20, s37, 1
    s_lshl_b32 s20, s20, 3
    s_and_b32 s39, s38, 7
    s_add_u32 s20, s20, s39
    s_lshr_b32 s21, s37, 1
    s_lshl_b32 s21, s21, 2
    s_lshr_b32 s39, s38, 3
    s_add_u32 s21, s21, s39
L_b1_task:
    s_load_dwordx2 s[56:57], s[0:1], 0
    s_load_dwordx4 s[60:63], s[0:1], 32
    v_lshrrev_b32 v24, 6, v0
    v_and_b32 v2, 63, v0
    s_nop 0
    v_readfirstlane_b32 s23, v24
    v_and_b32 v3, 31, v2
    v_lshrrev_b32 v1, 5, v2
    s_and_b32 s24, s23, 3
    s_lshr_b32 s25, s23, 2
    s_mul_i32 s27, s21, 96
    s_mul_i32 s35, s21, 24
    s_mov_b32 s26, 3072
    s_min_u32 s37, s23, 5
    s_lshl_b32 s28, s37, 10
    v_lshl_add_u32 v24, v2, 4, s28
    v_lshrrev_b32 v25, 6, v24
    v_mul_u32_u24 v25, 21846, v25
    v_lshrrev_b32 v25, 16, v25
    v_mul_u32_u24 v26, 192, v25
    v_sub_u32 v26, v24, v26
    v_mul_lo_u32 v25, v25, s26
    s_lshl_b32 s37, s27, 1
    v_add3_u32 v4, v25, v26, s37
    s_lshl_b32 s49, s23, 10
    s_lshl_b32 s37, s23, 4
    v_lshrrev_b32 v24, 2, v2
    v_add_u32 v24, s37, v24
    v_bfe_u32 v25, v24, 2, 2
    v_and_b32 v26, 3, v2
    v_xor_b32 v25, v25, v26
    s_lshl_b32 s38, s20, 7
    v_add_u32 v24, s38, v24
    v_mul_u32_u24 v24, 1280, v24
    v_lshl_add_u32 v5, v25, 4, v24
    s_lshl_b32 s33, s26, 5
    s_lshl_b32 s37, s25, 1
    s_and_b32 s38, s24, 1
    s_cmp_eq_u32 s25, 0
    s_cselect_b32 s38, s38, 0
    s_add_u32 s40, s37, s38
    s_xor_b32 s41, s40, 1
    s_lshl_b32 s49, s23, 11
    s_lshl_b32 s37, s23, 4
    s_add_u32 s37, s37, 0
    v_lshrrev_b32 v24, 3, v2
    v_add_u32 v24, s37, v24
    v_bfe_u32 v25, v24, 1, 3
    v_and_b32 v26, 7, v2
    v_xor_b32 v25, v25, v26
    s_lshl_b32 s38, s20, 7
    v_add_u32 v24, s38, v24
    v_mul_u32_u24 v24, 1280, v24
    v_lshl_add_u32 v5, v25, 4, v24
    s_lshl_b32 s37, s23, 4
    s_add_u32 s37, s37, 8
    v_lshrrev_b32 v24, 3, v2
    v_add_u32 v24, s37, v24
    v_bfe_u32 v25, v24, 1, 3
    v_and_b32 v26, 7, v2
    v_xor_b32 v25, v25, v26
    s_lshl_b32 s38, s20, 7
    v_add_u32 v24, s38, v24
    v_mul_u32_u24 v24, 1280, v24
    v_lshl_add_u32 v11, v25, 4, v24
    s_waitcnt lgkmcnt(0)
    s_add_u32 s8, s56, 0
    s_addc_u32 s9, s57, 0
    s_mov_b32 s10, 2621440
    s_mov_b32 s11, 0x00020000
    s_add_u32 s12, s60, 0
    s_addc_u32 s13, s61, 0
    s_mov_b32 s14, 1966080
    s_mov_b32 s15, 0x00020000
    s_add_u32 s16, s4, 9437184
    s_addc_u32 s17, s5, 0
    s_mov_b32 s18, 6291456
    s_mov_b32 s19, 0x00020000
    s_add_u32 s44, s62, 0
    s_addc_u32 s45, s63, 0
    s_mov_b32 s46, 3072
    s_mov_b32 s47, 0x00020000
    s_lshl_b32 s37, s40, 5
    s_add_u32 s37, s37, s27
    v_add_u32 v24, s37, v3
    v_lshlrev_b32 v24, 1, v24
    buffer_load_ushort v10, v24, s[44:47], 0 offen
    s_cmp_eq_u32 s25, 0
    s_cbranch_scc0 L_b1_j1
    s_mov_b32 s48, 0
    s_mov_b32 s34, 0
    s_add_u32 m0, s49, 0
    s_nop 0
    buffer_load_dwordx4 v5, s[8:11], s48 offen lds
    s_add_u32 m0, s49, 1024
    s_nop 0
    buffer_load_dwordx4 v11, s[8:11], s48 offen lds
    s_add_u32 s48, s48, 128
    s_add_u32 m0, s28, 32768
    s_nop 0
    buffer_load_dwordx4 v4, s[12:15], s34 offen lds
    s_add_u32 s34, s34, s33
    s_add_u32 m0, s28, 38912
    s_nop 0
    buffer_load_dwordx4 v4, s[12:15], s34 offen lds
    s_add_u32 s34, s34, s33
    s_add_u32 m0, s49, 16384
    s_nop 0
    buffer_load_dwordx4 v5, s[8:11], s48 offen lds
    s_add_u32 m0, s49, 17408
    s_nop 0
    buffer_load_dwordx4 v11, s[8:11], s48 offen lds
    s_add_u32 s48, s48, 128
    s_add_u32 m0, s28, 45056
    s_nop 0
    buffer_load_dwordx4 v4, s[12:15], s34 offen lds
    s_add_u32 s34, s34, s33
    s_add_u32 m0, s28, 51200
    s_nop 0
    buffer_load_dwordx4 v4, s[12:15], s34 offen lds
    s_add_u32 s34, s34, s33
    s_lshl_b32 s37, s24, 5
    v_add_u32 v24, s37, v3
    v_bfe_u32 v25, v24, 2, 2
    v_lshlrev_b32 v24, 6, v24
    v_add_u32 v26, 0, v1
    v_xor_b32 v26, v26, v25
    v_lshl_add_u32 v8, v26, 4, v24
    v_add_u32 v26, 2, v1
    v_xor_b32 v26, v26, v25
    v_lshl_add_u32 v9, v26, 4, v24
    v_bfe_u32 v24, v2, 2, 2
    v_lshl_add_u32 v27, v1, 3, v24
    v_mul_u32_u24 v27, 192, v27
    v_and_b32 v25, 3, v2
    v_lshl_add_u32 v27, v25, 3, v27
    v_bfe_u32 v25, v2, 4, 1
    v_lshl_add_u32 v27, v25, 5, v27
    s_lshl_b32 s37, s40, 6
    s_add_u32 s37, s37, 32768
    v_add_u32 v6, s37, v27
    s_lshl_b32 s37, s41, 6
    s_add_u32 s37, s37, 32768
    v_add_u32 v7, s37, v27
    s_lshl_b32 s37, s24, 5
    v_add_u32 v24, s37, v3
    v_bfe_u32 v25, v24, 1, 3
    v_lshlrev_b32 v24, 7, v24
    v_add_u32 v26, 0, v1
    v_xor_b32 v26, v26, v25
    v_lshl_add_u32 v8, v26, 4, v24
    v_add_u32 v26, 2, v1
    v_xor_b32 v26, v26, v25
    v_lshl_add_u32 v9, v26, 4, v24
    v_add_u32 v26, 4, v1
    v_xor_b32 v26, v26, v25
    v_lshl_add_u32 v14, v26, 4, v24
    v_add_u32 v26, 6, v1
    v_xor_b32 v26, v26, v25
    v_lshl_add_u32 v15, v26, 4, v24
    v_and_b32 v24, 15, v2
    v_lshrrev_b32 v25, 4, v2
    v_cmp_eq_u32 vcc, v24, v25
    v_mov_b32 v26, 0x3f803f80
    s_nop 0
    v_cndmask_b32 v20, 0, v26, vcc
    v_cndmask_b32 v21, 0, v26, vcc
    v_cndmask_b32 v22, 0, v26, vcc
    v_cndmask_b32 v23, 0, v26, vcc
    v_mov_b32 v32, 0
    v_mov_b32 v33, 0
    v_mov_b32 v34, 0
    v_mov_b32 v35, 0
    v_mov_b32 v16, 0
    v_mov_b32 v17, 0
    v_mov_b32 v18, 0
    v_mov_b32 v19, 0
    v_mov_b32 v40, 0
    v_mov_b32 v41, 0
    v_mov_b32 v42, 0
    v_mov_b32 v43, 0
    v_mov_b32 v44, 0
    v_mov_b32 v45, 0
    v_mov_b32 v46, 0
    v_mov_b32 v47, 0
    v_mov_b32 v48, 0
    v_mov_b32 v49, 0
    v_mov_b32 v50, 0
    v_mov_b32 v51, 0
    v_mov_b32 v52, 0
    v_mov_b32 v53, 0
    v_mov_b32 v54, 0
    v_mov_b32 v55, 0
    v_mov_b32 v56, 0
    v_mov_b32 v57, 0
    v_mov_b32 v58, 0
    v_mov_b32 v59, 0
    v_mov_b32 v60, 0
    v_mov_b32 v61, 0
    v_mov_b32 v62, 0
    v_mov_b32 v63, 0
    v_mov_b32 v64, 0
    v_mov_b32 v65, 0
    v_mov_b32 v66, 0
    v_mov_b32 v67, 0
    v_mov_b32 v68, 0
    v_mov_b32 v69, 0
    v_mov_b32 v70, 0
    v_mov_b32 v71, 0
    s_cmp_lt_u32 s24, 2
    s_cselect_b64 vcc, -1, 0
    s_mov_b32 s42, 0
    s_waitcnt vmcnt(5)
    s_barrier
    ds_read_b128 v[72:75], v8 offset:0
    ds_read_b64_tr_b16 v[80:81], v6 offset:0
    ds_read_b64_tr_b16 v[82:83], v6 offset:768
    ds_read_b64_tr_b16 v[84:85], v7 offset:0
    ds_read_b64_tr_b16 v[86:87], v7 offset:768
    ds_read_b128 v[76:79], v9 offset:0
    ds_read_b64_tr_b16 v[88:89], v6 offset:3072
    ds_read_b64_tr_b16 v[90:91], v6 offset:3840
    ds_read_b64_tr_b16 v[92:93], v7 offset:3072
    ds_read_b64_tr_b16 v[94:95], v7 offset:3840
L_b1a_loop:
    s_waitcnt lgkmcnt(0)
    s_waitcnt vmcnt(4)
    s_barrier
    ds_read_b128 v[96:99], v14 offset:0
    ds_read_b64_tr_b16 v[104:105], v6 offset:6144
    ds_read_b64_tr_b16 v[106:107], v6 offset:6912
    ds_read_b64_tr_b16 v[108:109], v7 offset:6144
    ds_read_b64_tr_b16 v[110:111], v7 offset:6912
    ds_read_b128 v[100:103], v15 offset:0
    ds_read_b64_tr_b16 v[112:113], v6 offset:9216
    ds_read_b64_tr_b16 v[114:115], v6 offset:9984
    ds_read_b64_tr_b16 v[116:117], v7 offset:9216
    ds_read_b64_tr_b16 v[118:119], v7 offset:9984
    v_mfma_f32_32x32x16_bf16 v[40:55], v[80:83], v[72:75], v[40:55]
    s_add_u32 m0, s28, 32768
    s_nop 0
    buffer_load_dwordx4 v4, s[12:15], s34 offen lds
    s_add_u32 s34, s34, s33
    v_lshlrev_b32 v36, 16, v72
    v_and_b32 v37, 0xffff0000, v72
    v_add_f32 v32, v32, v36
    v_add_f32 v33, v33, v37
    v_fmac_f32 v34, v36, v36
    v_fmac_f32 v35, v37, v37
    v_mfma_f32_32x32x16_bf16 v[56:71], v[84:87], v[72:75], v[56:71]
    v_lshlrev_b32 v38, 16, v73
    v_and_b32 v39, 0xffff0000, v73
    v_add_f32 v32, v32, v38
    v_add_f32 v33, v33, v39
    v_fmac_f32 v34, v38, v38
    v_fmac_f32 v35, v39, v39
    v_mfma_f32_32x32x16_bf16 v[40:55], v[88:91], v[76:79], v[40:55]
    v_lshlrev_b32 v36, 16, v76
    v_and_b32 v37, 0xffff0000, v76
    v_add_f32 v32, v32, v36
    v_add_f32 v33, v33, v37
    v_fmac_f32 v34, v36, v36
    v_fmac_f32 v35, v37, v37
    v_mfma_f32_32x32x16_bf16 v[56:71], v[92:95], v[76:79], v[56:71]
    v_lshlrev_b32 v38, 16, v77
    v_and_b32 v39, 0xffff0000, v77
    v_add_f32 v32, v32, v38
    v_add_f32 v33, v33, v39
    v_fmac_f32 v34, v38, v38
    v_fmac_f32 v35, v39, v39
    s_cbranch_vccz L_b1a_ns0
    v_mfma_f32_16x16x32_bf16 v[16:19], v[80:83], v[20:23], v[16:19]
    v_mfma_f32_16x16x32_bf16 v[16:19], v[88:91], v[20:23], v[16:19]
L_b1a_ns0:
    s_waitcnt lgkmcnt(0)
    s_waitcnt vmcnt(1)
    s_barrier
    ds_read_b128 v[72:75], v8 offset:16384
    ds_read_b64_tr_b16 v[80:81], v6 offset:12288
    ds_read_b64_tr_b16 v[82:83], v6 offset:13056
    ds_read_b64_tr_b16 v[84:85], v7 offset:12288
    ds_read_b64_tr_b16 v[86:87], v7 offset:13056
    ds_read_b128 v[76:79], v9 offset:16384
    ds_read_b64_tr_b16 v[88:89], v6 offset:15360
    ds_read_b64_tr_b16 v[90:91], v6 offset:16128
    ds_read_b64_tr_b16 v[92:93], v7 offset:15360
    ds_read_b64_tr_b16 v[94:95], v7 offset:16128
    v_mfma_f32_32x32x16_bf16 v[40:55], v[104:107], v[96:99], v[40:55]
    s_add_u32 m0, s49, 0
    s_nop 0
    buffer_load_dwordx4 v5, s[8:11], s48 offen lds
    v_lshlrev_b32 v36, 16, v96
    v_and_b32 v37, 0xffff0000, v96
    v_add_f32 v32, v32, v36
    v_add_f32 v33, v33, v37
    v_fmac_f32 v34, v36, v36
    v_fmac_f32 v35, v37, v37
    v_mfma_f32_32x32x16_bf16 v[56:71], v[108:111], v[96:99], v[56:71]
    s_add_u32 m0, s49, 1024
    s_nop 0
    buffer_load_dwordx4 v11, s[8:11], s48 offen lds
    s_add_u32 s48, s48, 128
    v_lshlrev_b32 v38, 16, v97
    v_and_b32 v39, 0xffff0000, v97
    v_add_f32 v32, v32, v38
    v_add_f32 v33, v33, v39
    v_fmac_f32 v34, v38, v38
    v_fmac_f32 v35, v39, v39
    v_mfma_f32_32x32x16_bf16 v[40:55], v[112:115], v[100:103], v[40:55]
    s_add_u32 m0, s28, 38912
    s_nop 0
    buffer_load_dwordx4 v4, s[12:15], s34 offen lds
    s_add_u32 s34, s34, s33
    v_lshlrev_b32 v36, 16, v100
    v_and_b32 v37, 0xffff0000, v100
    v_add_f32 v32, v32, v36
    v_add_f32 v33, v33, v37
    v_fmac_f32 v34, v36, v36
    v_fmac_f32 v35, v37, v37
    v_mfma_f32_32x32x16_bf16 v[56:71], v[116:119], v[100:103], v[56:71]
    v_lshlrev_b32 v38, 16, v101
    v_and_b32 v39, 0xffff0000, v101
    v_add_f32 v32, v32, v38
    v_add_f32 v33, v33, v39
    v_fmac_f32 v34, v38, v38
    v_fmac_f32 v35, v39, v39
    s_cbranch_vccz L_b1a_ns1
    v_mfma_f32_16x16x32_bf16 v[16:19], v[104:107], v[20:23], v[16:19]
    v_mfma_f32_16x16x32_bf16 v[16:19], v[112:115], v[20:23], v[16:19]
L_b1a_ns1:
    s_waitcnt lgkmcnt(0)
    s_waitcnt vmcnt(4)
    s_barrier
    ds_read_b128 v[96:99], v14 offset:16384
    ds_read_b64_tr_b16 v[104:105], v6 offset:18432
    ds_read_b64_tr_b16 v[106:107], v6 offset:19200
    ds_read_b64_tr_b16 v[108:109], v7 offset:18432
    ds_read_b64_tr_b16 v[110:111], v7 offset:19200
    ds_read_b128 v[100:103], v15 offset:16384
    ds_read_b64_tr_b16 v[112:113], v6 offset:21504
    ds_read_b64_tr_b16 v[114:115], v6 offset:22272
    ds_read_b64_tr_b16 v[116:117], v7 offset:21504
    ds_read_b64_tr_b16 v[118:119], v7 offset:22272
    v_mfma_f32_32x32x16_bf16 v[40:55], v[80:83], v[72:75], v[40:55]
    s_add_u32 m0, s28, 45056
    s_nop 0
    buffer_load_dwordx4 v4, s[12:15], s34 offen lds
    s_add_u32 s34, s34, s33
    v_lshlrev_b32 v36, 16, v72
    v_and_b32 v37, 0xffff0000, v72
    v_add_f32 v32, v32, v36
    v_add_f32 v33, v33, v37
    v_fmac_f32 v34, v36, v36
    v_fmac_f32 v35, v37, v37
    v_mfma_f32_32x32x16_bf16 v[56:71], v[84:87], v[72:75], v[56:71]
    v_lshlrev_b32 v38, 16, v73
    v_and_b32 v39, 0xffff0000, v73
    v_add_f32 v32, v32, v38
    v_add_f32 v33, v33, v39
    v_fmac_f32 v34, v38, v38
    v_fmac_f32 v35, v39, v39
    v_mfma_f32_32x32x16_bf16 v[40:55], v[88:91], v[76:79], v[40:55]
    v_lshlrev_b32 v36, 16, v76
    v_and_b32 v37, 0xffff0000, v76
    v_add_f32 v32, v32, v36
    v_add_f32 v33, v33, v37
    v_fmac_f32 v34, v36, v36
    v_fmac_f32 v35, v37, v37
    v_mfma_f32_32x32x16_bf16 v[56:71], v[92:95], v[76:79], v[56:71]
    v_lshlrev_b32 v38, 16, v77
    v_and_b32 v39, 0xffff0000, v77
    v_add_f32 v32, v32, v38
    v_add_f32 v33, v33, v39
    v_fmac_f32 v34, v38, v38
    v_fmac_f32 v35, v39, v39
    s_cbranch_vccz L_b1a_ns2
    v_mfma_f32_16x16x32_bf16 v[16:19], v[80:83], v[20:23], v[16:19]
    v_mfma_f32_16x16x32_bf16 v[16:19], v[88:91], v[20:23], v[16:19]
L_b1a_ns2:
    s_waitcnt lgkmcnt(0)
    s_waitcnt vmcnt(1)
    s_barrier
    ds_read_b128 v[72:75], v8 offset:0
    ds_read_b64_tr_b16 v[80:81], v6 offset:0
    ds_read_b64_tr_b16 v[82:83], v6 offset:768
    ds_read_b64_tr_b16 v[84:85], v7 offset:0
    ds_read_b64_tr_b16 v[86:87], v7 offset:768
    ds_read_b128 v[76:79], v9 offset:0
    ds_read_b64_tr_b16 v[88:89], v6 offset:3072
    ds_read_b64_tr_b16 v[90:91], v6 offset:3840
    ds_read_b64_tr_b16 v[92:93], v7 offset:3072
    ds_read_b64_tr_b16 v[94:95], v7 offset:3840
    v_mfma_f32_32x32x16_bf16 v[40:55], v[104:107], v[96:99], v[40:55]
    s_add_u32 m0, s49, 16384
    s_nop 0
    buffer_load_dwordx4 v5, s[8:11], s48 offen lds
    v_lshlrev_b32 v36, 16, v96
    v_and_b32 v37, 0xffff0000, v96
    v_add_f32 v32, v32, v36
    v_add_f32 v33, v33, v37
    v_fmac_f32 v34, v36, v36
    v_fmac_f32 v35, v37, v37
    v_mfma_f32_32x32x16_bf16 v[56:71], v[108:111], v[96:99], v[56:71]
    s_add_u32 m0, s49, 17408
    s_nop 0
    buffer_load_dwordx4 v11, s[8:11], s48 offen lds
    s_add_u32 s48, s48, 128
    v_lshlrev_b32 v38, 16, v97
    v_and_b32 v39, 0xffff0000, v97
    v_add_f32 v32, v32, v38
    v_add_f32 v33, v33, v39
    v_fmac_f32 v34, v38, v38
    v_fmac_f32 v35, v39, v39
    v_mfma_f32_32x32x16_bf16 v[40:55], v[112:115], v[100:103], v[40:55]
    s_add_u32 m0, s28, 51200
    s_nop 0
    buffer_load_dwordx4 v4, s[12:15], s34 offen lds
    s_add_u32 s34, s34, s33
    v_lshlrev_b32 v36, 16, v100
    v_and_b32 v37, 0xffff0000, v100
    v_add_f32 v32, v32, v36
    v_add_f32 v33, v33, v37
    v_fmac_f32 v34, v36, v36
    v_fmac_f32 v35, v37, v37
    v_mfma_f32_32x32x16_bf16 v[56:71], v[116:119], v[100:103], v[56:71]
    v_lshlrev_b32 v38, 16, v101
    v_and_b32 v39, 0xffff0000, v101
    v_add_f32 v32, v32, v38
    v_add_f32 v33, v33, v39
    v_fmac_f32 v34, v38, v38
    v_fmac_f32 v35, v39, v39
    s_cbranch_vccz L_b1a_ns3
    v_mfma_f32_16x16x32_bf16 v[16:19], v[104:107], v[20:23], v[16:19]
    v_mfma_f32_16x16x32_bf16 v[16:19], v[112:115], v[20:23], v[16:19]
L_b1a_ns3:
    s_add_u32 s42, s42, 1
    s_cmp_lt_u32 s42, 4
    s_cbranch_scc1 L_b1a_loop
    s_waitcnt lgkmcnt(0)
    s_waitcnt vmcnt(3)
    s_barrier
    ds_read_b128 v[96:99], v14 offset:0
    ds_read_b64_tr_b16 v[104:105], v6 offset:6144
    ds_read_b64_tr_b16 v[106:107], v6 offset:6912
    ds_read_b64_tr_b16 v[108:109], v7 offset:6144
    ds_read_b64_tr_b16 v[110:111], v7 offset:6912
    ds_read_b128 v[100:103], v15 offset:0
    ds_read_b64_tr_b16 v[112:113], v6 offset:9216
    ds_read_b64_tr_b16 v[114:115], v6 offset:9984
    ds_read_b64_tr_b16 v[116:117], v7 offset:9216
    ds_read_b64_tr_b16 v[118:119], v7 offset:9984
    v_mfma_f32_32x32x16_bf16 v[40:55], v[80:83], v[72:75], v[40:55]
    v_lshlrev_b32 v36, 16, v72
    v_and_b32 v37, 0xffff0000, v72
    v_add_f32 v32, v32, v36
    v_add_f32 v33, v33, v37
    v_fmac_f32 v34, v36, v36
    v_fmac_f32 v35, v37, v37
    v_mfma_f32_32x32x16_bf16 v[56:71], v[84:87], v[72:75], v[56:71]
    v_lshlrev_b32 v38, 16, v73
    v_and_b32 v39, 0xffff0000, v73
    v_add_f32 v32, v32, v38
    v_add_f32 v33, v33, v39
    v_fmac_f32 v34, v38, v38
    v_fmac_f32 v35, v39, v39
    v_mfma_f32_32x32x16_bf16 v[40:55], v[88:91], v[76:79], v[40:55]
    v_lshlrev_b32 v36, 16, v76
    v_and_b32 v37, 0xffff0000, v76
    v_add_f32 v32, v32, v36
    v_add_f32 v33, v33, v37
    v_fmac_f32 v34, v36, v36
    v_fmac_f32 v35, v37, v37
    v_mfma_f32_32x32x16_bf16 v[56:71], v[92:95], v[76:79], v[56:71]
    v_lshlrev_b32 v38, 16, v77
    v_and_b32 v39, 0xffff0000, v77
    v_add_f32 v32, v32, v38
    v_add_f32 v33, v33, v39
    v_fmac_f32 v34, v38, v38
    v_fmac_f32 v35, v39, v39
    s_cbranch_vccz L_b1a_ns16
    v_mfma_f32_16x16x32_bf16 v[16:19], v[80:83], v[20:23], v[16:19]
    v_mfma_f32_16x16x32_bf16 v[16:19], v[88:91], v[20:23], v[16:19]
L_b1a_ns16:
    s_waitcnt lgkmcnt(0)
    s_waitcnt vmcnt(0)
    s_barrier
    ds_read_b128 v[72:75], v8 offset:16384
    ds_read_b64_tr_b16 v[80:81], v6 offset:12288
    ds_read_b64_tr_b16 v[82:83], v6 offset:13056
    ds_read_b64_tr_b16 v[84:85], v7 offset:12288
    ds_read_b64_tr_b16 v[86:87], v7 offset:13056
    ds_read_b128 v[76:79], v9 offset:16384
    ds_read_b64_tr_b16 v[88:89], v6 offset:15360
    ds_read_b64_tr_b16 v[90:91], v6 offset:16128
    ds_read_b64_tr_b16 v[92:93], v7 offset:15360
    ds_read_b64_tr_b16 v[94:95], v7 offset:16128
    v_mfma_f32_32x32x16_bf16 v[40:55], v[104:107], v[96:99], v[40:55]
    v_lshlrev_b32 v36, 16, v96
    v_and_b32 v37, 0xffff0000, v96
    v_add_f32 v32, v32, v36
    v_add_f32 v33, v33, v37
    v_fmac_f32 v34, v36, v36
    v_fmac_f32 v35, v37, v37
    v_mfma_f32_32x32x16_bf16 v[56:71], v[108:111], v[96:99], v[56:71]
    v_lshlrev_b32 v38, 16, v97
    v_and_b32 v39, 0xffff0000, v97
    v_add_f32 v32, v32, v38
    v_add_f32 v33, v33, v39
    v_fmac_f32 v34, v38, v38
    v_fmac_f32 v35, v39, v39
    v_mfma_f32_32x32x16_bf16 v[40:55], v[112:115], v[100:103], v[40:55]
    v_lshlrev_b32 v36, 16, v100
    v_and_b32 v37, 0xffff0000, v100
    v_add_f32 v32, v32, v36
    v_add_f32 v33, v33, v37
    v_fmac_f32 v34, v36, v36
    v_fmac_f32 v35, v37, v37
    v_mfma_f32_32x32x16_bf16 v[56:71], v[116:119], v[100:103], v[56:71]
    v_lshlrev_b32 v38, 16, v101
    v_and_b32 v39, 0xffff0000, v101
    v_add_f32 v32, v32, v38
    v_add_f32 v33, v33, v39
    v_fmac_f32 v34, v38, v38
    v_fmac_f32 v35, v39, v39
    s_cbranch_vccz L_b1a_ns17
    v_mfma_f32_16x16x32_bf16 v[16:19], v[104:107], v[20:23], v[16:19]
    v_mfma_f32_16x16x32_bf16 v[16:19], v[112:115], v[20:23], v[16:19]
L_b1a_ns17:
    s_waitcnt lgkmcnt(0)
    s_waitcnt vmcnt(0)
    s_barrier
    ds_read_b128 v[96:99], v14 offset:16384
    ds_read_b64_tr_b16 v[104:105], v6 offset:18432
    ds_read_b64_tr_b16 v[106:107], v6 offset:19200
    ds_read_b64_tr_b16 v[108:109], v7 offset:18432
    ds_read_b64_tr_b16 v[110:111], v7 offset:19200
    ds_read_b128 v[100:103], v15 offset:16384
    ds_read_b64_tr_b16 v[112:113], v6 offset:21504
    ds_read_b64_tr_b16 v[114:115], v6 offset:22272
    ds_read_b64_tr_b16 v[116:117], v7 offset:21504
    ds_read_b64_tr_b16 v[118:119], v7 offset:22272
    v_mfma_f32_32x32x16_bf16 v[40:55], v[80:83], v[72:75], v[40:55]
    v_lshlrev_b32 v36, 16, v72
    v_and_b32 v37, 0xffff0000, v72
    v_add_f32 v32, v32, v36
    v_add_f32 v33, v33, v37
    v_fmac_f32 v34, v36, v36
    v_fmac_f32 v35, v37, v37
    v_mfma_f32_32x32x16_bf16 v[56:71], v[84:87], v[72:75], v[56:71]
    v_lshlrev_b32 v38, 16, v73
    v_and_b32 v39, 0xffff0000, v73
    v_add_f32 v32, v32, v38
    v_add_f32 v33, v33, v39
    v_fmac_f32 v34, v38, v38
    v_fmac_f32 v35, v39, v39
    v_mfma_f32_32x32x16_bf16 v[40:55], v[88:91], v[76:79], v[40:55]
    v_lshlrev_b32 v36, 16, v76
    v_and_b32 v37, 0xffff0000, v76
    v_add_f32 v32, v32, v36
    v_add_f32 v33, v33, v37
    v_fmac_f32 v34, v36, v36
    v_fmac_f32 v35, v37, v37
    v_mfma_f32_32x32x16_bf16 v[56:71], v[92:95], v[76:79], v[56:71]
    v_lshlrev_b32 v38, 16, v77
    v_and_b32 v39, 0xffff0000, v77
    v_add_f32 v32, v32, v38
    v_add_f32 v33, v33, v39
    v_fmac_f32 v34, v38, v38
    v_fmac_f32 v35, v39, v39
    s_cbranch_vccz L_b1a_ns18
    v_mfma_f32_16x16x32_bf16 v[16:19], v[80:83], v[20:23], v[16:19]
    v_mfma_f32_16x16x32_bf16 v[16:19], v[88:91], v[20:23], v[16:19]
L_b1a_ns18:
    s_waitcnt lgkmcnt(0)
    v_mfma_f32_32x32x16_bf16 v[40:55], v[104:107], v[96:99], v[40:55]
    v_lshlrev_b32 v36, 16, v96
    v_and_b32 v37, 0xffff0000, v96
    v_add_f32 v32, v32, v36
    v_add_f32 v33, v33, v37
    v_fmac_f32 v34, v36, v36
    v_fmac_f32 v35, v37, v37
    v_mfma_f32_32x32x16_bf16 v[56:71], v[108:111], v[96:99], v[56:71]
    v_lshlrev_b32 v38, 16, v97
    v_and_b32 v39, 0xffff0000, v97
    v_add_f32 v32, v32, v38
    v_add_f32 v33, v33, v39
    v_fmac_f32 v34, v38, v38
    v_fmac_f32 v35, v39, v39
    v_mfma_f32_32x32x16_bf16 v[40:55], v[112:115], v[100:103], v[40:55]
    v_lshlrev_b32 v36, 16, v100
    v_and_b32 v37, 0xffff0000, v100
    v_add_f32 v32, v32, v36
    v_add_f32 v33, v33, v37
    v_fmac_f32 v34, v36, v36
    v_fmac_f32 v35, v37, v37
    v_mfma_f32_32x32x16_bf16 v[56:71], v[116:119], v[100:103], v[56:71]
    v_lshlrev_b32 v38, 16, v101
    v_and_b32 v39, 0xffff0000, v101
    v_add_f32 v32, v32, v38
    v_add_f32 v33, v33, v39
    v_fmac_f32 v34, v38, v38
    v_fmac_f32 v35, v39, v39
    s_cbranch_vccz L_b1a_ns19
    v_mfma_f32_16x16x32_bf16 v[16:19], v[104:107], v[20:23], v[16:19]
    v_mfma_f32_16x16x32_bf16 v[16:19], v[112:115], v[20:23], v[16:19]
L_b1a_ns19:
    s_branch L_b1_fin
L_b1_j1:
    s_mov_b32 s48, 0
    s_mov_b32 s34, 0
    s_add_u32 m0, s49, 0
    s_nop 0
    buffer_load_dwordx4 v5, s[8:11], s48 offen lds
    s_add_u32 m0, s49, 1024
    s_nop 0
    buffer_load_dwordx4 v11, s[8:11], s48 offen lds
    s_add_u32 s48, s48, 128
    s_add_u32 m0, s28, 32768
    s_nop 0
    buffer_load_dwordx4 v4, s[12:15], s34 offen lds
    s_add_u32 s34, s34, s33
    s_add_u32 m0, s28, 38912
    s_nop 0
    buffer_load_dwordx4 v4, s[12:15], s34 offen lds
    s_add_u32 s34, s34, s33
    s_add_u32 m0, s49, 16384
    s_nop 0
    buffer_load_dwordx4 v5, s[8:11], s48 offen lds
    s_add_u32 m0, s49, 17408
    s_nop 0
    buffer_load_dwordx4 v11, s[8:11], s48 offen lds
    s_add_u32 s48, s48, 128
    s_add_u32 m0, s28, 45056
    s_nop 0
    buffer_load_dwordx4 v4, s[12:15], s34 offen lds
    s_add_u32 s34, s34, s33
    s_add_u32 m0, s28, 51200
    s_nop 0
    buffer_load_dwordx4 v4, s[12:15], s34 offen lds
    s_add_u32 s34, s34, s33
    s_lshl_b32 s37, s24, 5
    v_add_u32 v24, s37, v3
    v_bfe_u32 v25, v24, 2, 2
    v_lshlrev_b32 v24, 6, v24
    v_add_u32 v26, 0, v1
    v_xor_b32 v26, v26, v25
    v_lshl_add_u32 v8, v26, 4, v24
    v_add_u32 v26, 2, v1
    v_xor_b32 v26, v26, v25
    v_lshl_add_u32 v9, v26, 4, v24
    v_bfe_u32 v24, v2, 2, 2
    v_lshl_add_u32 v27, v1, 3, v24
    v_mul_u32_u24 v27, 192, v27
    v_and_b32 v25, 3, v2
    v_lshl_add_u32 v27, v25, 3, v27
    v_bfe_u32 v25, v2, 4, 1
    v_lshl_add_u32 v27, v25, 5, v27
    s_lshl_b32 s37, s40, 6
    s_add_u32 s37, s37, 32768
    v_add_u32 v6, s37, v27
    s_lshl_b32 s37, s41, 6
    s_add_u32 s37, s37, 32768
    v_add_u32 v7, s37, v27
    s_lshl_b32 s37, s24, 5
    v_add_u32 v24, s37, v3
    v_bfe_u32 v25, v24, 1, 3
    v_lshlrev_b32 v24, 7, v24
    v_add_u32 v26, 0, v1
    v_xor_b32 v26, v26, v25
    v_lshl_add_u32 v8, v26, 4, v24
    v_add_u32 v26, 2, v1
    v_xor_b32 v26, v26, v25
    v_lshl_add_u32 v9, v26, 4, v24
    v_add_u32 v26, 4, v1
    v_xor_b32 v26, v26, v25
    v_lshl_add_u32 v14, v26, 4, v24
    v_add_u32 v26, 6, v1
    v_xor_b32 v26, v26, v25
    v_lshl_add_u32 v15, v26, 4, v24
    v_and_b32 v24, 15, v2
    v_lshrrev_b32 v25, 4, v2
    v_cmp_eq_u32 vcc, v24, v25
    v_mov_b32 v26, 0x3f803f80
    s_nop 0
    v_cndmask_b32 v20, 0, v26, vcc
    v_cndmask_b32 v21, 0, v26, vcc
    v_cndmask_b32 v22, 0, v26, vcc
    v_cndmask_b32 v23, 0, v26, vcc
    v_mov_b32 v32, 0
    v_mov_b32 v33, 0
    v_mov_b32 v34, 0
    v_mov_b32 v35, 0
    v_mov_b32 v16, 0
    v_mov_b32 v17, 0
    v_mov_b32 v18, 0
    v_mov_b32 v19, 0
    v_mov_b32 v40, 0
    v_mov_b32 v41, 0
    v_mov_b32 v42, 0
    v_mov_b32 v43, 0
    v_mov_b32 v44, 0
    v_mov_b32 v45, 0
    v_mov_b32 v46, 0
    v_mov_b32 v47, 0
    v_mov_b32 v48, 0
    v_mov_b32 v49, 0
    v_mov_b32 v50, 0
    v_mov_b32 v51, 0
    v_mov_b32 v52, 0
    v_mov_b32 v53, 0
    v_mov_b32 v54, 0
    v_mov_b32 v55, 0
    s_cmp_lt_u32 s24, 2
    s_cselect_b64 vcc, -1, 0
    s_mov_b32 s42, 0
    s_waitcnt vmcnt(5)
    s_barrier
    ds_read_b128 v[72:75], v8 offset:0
    ds_read_b64_tr_b16 v[80:81], v6 offset:0
    ds_read_b64_tr_b16 v[82:83], v6 offset:768
    ds_read_b128 v[76:79], v9 offset:0
    ds_read_b64_tr_b16 v[88:89], v6 offset:3072
    ds_read_b64_tr_b16 v[90:91], v6 offset:3840
L_b1b_loop:
    s_waitcnt lgkmcnt(0)
    s_waitcnt vmcnt(4)
    s_barrier
    ds_read_b128 v[96:99], v14 offset:0
    ds_read_b64_tr_b16 v[104:105], v6 offset:6144
    ds_read_b64_tr_b16 v[106:107], v6 offset:6912
    ds_read_b128 v[100:103], v15 offset:0
    ds_read_b64_tr_b16 v[112:113], v6 offset:9216
    ds_read_b64_tr_b16 v[114:115], v6 offset:9984
    v_mfma_f32_32x32x16_bf16 v[40:55], v[80:83], v[72:75], v[40:55]
    s_add_u32 m0, s28, 32768
    s_nop 0
    buffer_load_dwordx4 v4, s[12:15], s34 offen lds
    s_add_u32 s34, s34, s33
    v_lshlrev_b32 v36, 16, v74
    v_and_b32 v37, 0xffff0000, v74
    v_add_f32 v32, v32, v36
    v_add_f32 v33, v33, v37
    v_fmac_f32 v34, v36, v36
    v_fmac_f32 v35, v37, v37
    v_lshlrev_b32 v38, 16, v75
    v_and_b32 v39, 0xffff0000, v75
    v_add_f32 v32, v32, v38
    v_add_f32 v33, v33, v39
    v_fmac_f32 v34, v38, v38
    v_fmac_f32 v35, v39, v39
    v_mfma_f32_32x32x16_bf16 v[40:55], v[88:91], v[76:79], v[40:55]
    v_lshlrev_b32 v36, 16, v78
    v_and_b32 v37, 0xffff0000, v78
    v_add_f32 v32, v32, v36
    v_add_f32 v33, v33, v37
    v_fmac_f32 v34, v36, v36
    v_fmac_f32 v35, v37, v37
    v_lshlrev_b32 v38, 16, v79
    v_and_b32 v39, 0xffff0000, v79
    v_add_f32 v32, v32, v38
    v_add_f32 v33, v33, v39
    v_fmac_f32 v34, v38, v38
    v_fmac_f32 v35, v39, v39
    s_cbranch_vccz L_b1b_ns0
    v_mfma_f32_16x16x32_bf16 v[16:19], v[80:83], v[20:23], v[16:19]
    v_mfma_f32_16x16x32_bf16 v[16:19], v[88:91], v[20:23], v[16:19]
L_b1b_ns0:
    s_waitcnt lgkmcnt(0)
    s_waitcnt vmcnt(1)
    s_barrier
    ds_read_b128 v[72:75], v8 offset:16384
    ds_read_b64_tr_b16 v[80:81], v6 offset:12288
    ds_read_b64_tr_b16 v[82:83], v6 offset:13056
    ds_read_b128 v[76:79], v9 offset:16384
    ds_read_b64_tr_b16 v[88:89], v6 offset:15360
    ds_read_b64_tr_b16 v[90:91], v6 offset:16128
    v_mfma_f32_32x32x16_bf16 v[40:55], v[104:107], v[96:99], v[40:55]
    s_add_u32 m0, s49, 0
    s_nop 0
    buffer_load_dwordx4 v5, s[8:11], s48 offen lds
    s_add_u32 m0, s49, 1024
    s_nop 0
    buffer_load_dwordx4 v11, s[8:11], s48 offen lds
    s_add_u32 s48, s48, 128
    v_lshlrev_b32 v36, 16, v98
    v_and_b32 v37, 0xffff0000, v98
    v_add_f32 v32, v32, v36
    v_add_f32 v33, v33, v37
    v_fmac_f32 v34, v36, v36
    v_fmac_f32 v35, v37, v37
    v_lshlrev_b32 v38, 16, v99
    v_and_b32 v39, 0xffff0000, v99
    v_add_f32 v32, v32, v38
    v_add_f32 v33, v33, v39
    v_fmac_f32 v34, v38, v38
    v_fmac_f32 v35, v39, v39
    v_mfma_f32_32x32x16_bf16 v[40:55], v[112:115], v[100:103], v[40:55]
    s_add_u32 m0, s28, 38912
    s_nop 0
    buffer_load_dwordx4 v4, s[12:15], s34 offen lds
    s_add_u32 s34, s34, s33
    v_lshlrev_b32 v36, 16, v102
    v_and_b32 v37, 0xffff0000, v102
    v_add_f32 v32, v32, v36
    v_add_f32 v33, v33, v37
    v_fmac_f32 v34, v36, v36
    v_fmac_f32 v35, v37, v37
    v_lshlrev_b32 v38, 16, v103
    v_and_b32 v39, 0xffff0000, v103
    v_add_f32 v32, v32, v38
    v_add_f32 v33, v33, v39
    v_fmac_f32 v34, v38, v38
    v_fmac_f32 v35, v39, v39
    s_cbranch_vccz L_b1b_ns1
    v_mfma_f32_16x16x32_bf16 v[16:19], v[104:107], v[20:23], v[16:19]
    v_mfma_f32_16x16x32_bf16 v[16:19], v[112:115], v[20:23], v[16:19]
L_b1b_ns1:
    s_waitcnt lgkmcnt(0)
    s_waitcnt vmcnt(4)
    s_barrier
    ds_read_b128 v[96:99], v14 offset:16384
    ds_read_b64_tr_b16 v[104:105], v6 offset:18432
    ds_read_b64_tr_b16 v[106:107], v6 offset:19200
    ds_read_b128 v[100:103], v15 offset:16384
    ds_read_b64_tr_b16 v[112:113], v6 offset:21504
    ds_read_b64_tr_b16 v[114:115], v6 offset:22272
    v_mfma_f32_32x32x16_bf16 v[40:55], v[80:83], v[72:75], v[40:55]
    s_add_u32 m0, s28, 45056
    s_nop 0
    buffer_load_dwordx4 v4, s[12:15], s34 offen lds
    s_add_u32 s34, s34, s33
    v_lshlrev_b32 v36, 16, v74
    v_and_b32 v37, 0xffff0000, v74
    v_add_f32 v32, v32, v36
    v_add_f32 v33, v33, v37
    v_fmac_f32 v34, v36, v36
    v_fmac_f32 v35, v37, v37
    v_lshlrev_b32 v38, 16, v75
    v_and_b32 v39, 0xffff0000, v75
    v_add_f32 v32, v32, v38
    v_add_f32 v33, v33, v39
    v_fmac_f32 v34, v38, v38
    v_fmac_f32 v35, v39, v39
    v_mfma_f32_32x32x16_bf16 v[40:55], v[88:91], v[76:79], v[40:55]
    v_lshlrev_b32 v36, 16, v78
    v_and_b32 v37, 0xffff0000, v78
    v_add_f32 v32, v32, v36
    v_add_f32 v33, v33, v37
    v_fmac_f32 v34, v36, v36
    v_fmac_f32 v35, v37, v37
    v_lshlrev_b32 v38, 16, v79
    v_and_b32 v39, 0xffff0000, v79
    v_add_f32 v32, v32, v38
    v_add_f32 v33, v33, v39
    v_fmac_f32 v34, v38, v38
    v_fmac_f32 v35, v39, v39
    s_cbranch_vccz L_b1b_ns2
    v_mfma_f32_16x16x32_bf16 v[16:19], v[80:83], v[20:23], v[16:19]
    v_mfma_f32_16x16x32_bf16 v[16:19], v[88:91], v[20:23], v[16:19]
L_b1b_ns2:
    s_waitcnt lgkmcnt(0)
    s_waitcnt vmcnt(1)
    s_barrier
    ds_read_b128 v[72:75], v8 offset:0
    ds_read_b64_tr_b16 v[80:81], v6 offset:0
    ds_read_b64_tr_b16 v[82:83], v6 offset:768
    ds_read_b128 v[76:79], v9 offset:0
    ds_read_b64_tr_b16 v[88:89], v6 offset:3072
    ds_read_b64_tr_b16 v[90:91], v6 offset:3840
    v_mfma_f32_32x32x16_bf16 v[40:55], v[104:107], v[96:99], v[40:55]
    s_add_u32 m0, s49, 16384
    s_nop 0
    buffer_load_dwordx4 v5, s[8:11], s48 offen lds
    s_add_u32 m0, s49, 17408
    s_nop 0
    buffer_load_dwordx4 v11, s[8:11], s48 offen lds
    s_add_u32 s48, s48, 128
    v_lshlrev_b32 v36, 16, v98
    v_and_b32 v37, 0xffff0000, v98
    v_add_f32 v32, v32, v36
    v_add_f32 v33, v33, v37
    v_fmac_f32 v34, v36, v36
    v_fmac_f32 v35, v37, v37
    v_lshlrev_b32 v38, 16, v99
    v_and_b32 v39, 0xffff0000, v99
    v_add_f32 v32, v32, v38
    v_add_f32 v33, v33, v39
    v_fmac_f32 v34, v38, v38
    v_fmac_f32 v35, v39, v39
    v_mfma_f32_32x32x16_bf16 v[40:55], v[112:115], v[100:103], v[40:55]
    s_add_u32 m0, s28, 51200
    s_nop 0
    buffer_load_dwordx4 v4, s[12:15], s34 offen lds
    s_add_u32 s34, s34, s33
    v_lshlrev_b32 v36, 16, v102
    v_and_b32 v37, 0xffff0000, v102
    v_add_f32 v32, v32, v36
    v_add_f32 v33, v33, v37
    v_fmac_f32 v34, v36, v36
    v_fmac_f32 v35, v37, v37
    v_lshlrev_b32 v38, 16, v103
    v_and_b32 v39, 0xffff0000, v103
    v_add_f32 v32, v32, v38
    v_add_f32 v33, v33, v39
    v_fmac_f32 v34, v38, v38
    v_fmac_f32 v35, v39, v39
    s_cbranch_vccz L_b1b_ns3
    v_mfma_f32_16x16x32_bf16 v[16:19], v[104:107], v[20:23], v[16:19]
    v_mfma_f32_16x16x32_bf16 v[16:19], v[112:115], v[20:23], v[16:19]
L_b1b_ns3:
    s_add_u32 s42, s42, 1
    s_cmp_lt_u32 s42, 4
    s_cbranch_scc1 L_b1b_loop
    s_waitcnt lgkmcnt(0)
    s_waitcnt vmcnt(3)
    s_barrier
    ds_read_b128 v[96:99], v14 offset:0
    ds_read_b64_tr_b16 v[104:105], v6 offset:6144
    ds_read_b64_tr_b16 v[106:107], v6 offset:6912
    ds_read_b128 v[100:103], v15 offset:0
    ds_read_b64_tr_b16 v[112:113], v6 offset:9216
    ds_read_b64_tr_b16 v[114:115], v6 offset:9984
    v_mfma_f32_32x32x16_bf16 v[40:55], v[80:83], v[72:75], v[40:55]
    v_lshlrev_b32 v36, 16, v74
    v_and_b32 v37, 0xffff0000, v74
    v_add_f32 v32, v32, v36
    v_add_f32 v33, v33, v37
    v_fmac_f32 v34, v36, v36
    v_fmac_f32 v35, v37, v37
    v_lshlrev_b32 v38, 16, v75
    v_and_b32 v39, 0xffff0000, v75
    v_add_f32 v32, v32, v38
    v_add_f32 v33, v33, v39
    v_fmac_f32 v34, v38, v38
    v_fmac_f32 v35, v39, v39
    v_mfma_f32_32x32x16_bf16 v[40:55], v[88:91], v[76:79], v[40:55]
    v_lshlrev_b32 v36, 16, v78
    v_and_b32 v37, 0xffff0000, v78
    v_add_f32 v32, v32, v36
    v_add_f32 v33, v33, v37
    v_fmac_f32 v34, v36, v36
    v_fmac_f32 v35, v37, v37
    v_lshlrev_b32 v38, 16, v79
    v_and_b32 v39, 0xffff0000, v79
    v_add_f32 v32, v32, v38
    v_add_f32 v33, v33, v39
    v_fmac_f32 v34, v38, v38
    v_fmac_f32 v35, v39, v39
    s_cbranch_vccz L_b1b_ns16
    v_mfma_f32_16x16x32_bf16 v[16:19], v[80:83], v[20:23], v[16:19]
    v_mfma_f32_16x16x32_bf16 v[16:19], v[88:91], v[20:23], v[16:19]
L_b1b_ns16:
    s_waitcnt lgkmcnt(0)
    s_waitcnt vmcnt(0)
    s_barrier
    ds_read_b128 v[72:75], v8 offset:16384
    ds_read_b64_tr_b16 v[80:81], v6 offset:12288
    ds_read_b64_tr_b16 v[82:83], v6 offset:13056
    ds_read_b128 v[76:79], v9 offset:16384
    ds_read_b64_tr_b16 v[88:89], v6 offset:15360
    ds_read_b64_tr_b16 v[90:91], v6 offset:16128
    v_mfma_f32_32x32x16_bf16 v[40:55], v[104:107], v[96:99], v[40:55]
    v_lshlrev_b32 v36, 16, v98
    v_and_b32 v37, 0xffff0000, v98
    v_add_f32 v32, v32, v36
    v_add_f32 v33, v33, v37
    v_fmac_f32 v34, v36, v36
    v_fmac_f32 v35, v37, v37
    v_lshlrev_b32 v38, 16, v99
    v_and_b32 v39, 0xffff0000, v99
    v_add_f32 v32, v32, v38
    v_add_f32 v33, v33, v39
    v_fmac_f32 v34, v38, v38
    v_fmac_f32 v35, v39, v39
    v_mfma_f32_32x32x16_bf16 v[40:55], v[112:115], v[100:103], v[40:55]
    v_lshlrev_b32 v36, 16, v102
    v_and_b32 v37, 0xffff0000, v102
    v_add_f32 v32, v32, v36
    v_add_f32 v33, v33, v37
    v_fmac_f32 v34, v36, v36
    v_fmac_f32 v35, v37, v37
    v_lshlrev_b32 v38, 16, v103
    v_and_b32 v39, 0xffff0000, v103
    v_add_f32 v32, v32, v38
    v_add_f32 v33, v33, v39
    v_fmac_f32 v34, v38, v38
    v_fmac_f32 v35, v39, v39
    s_cbranch_vccz L_b1b_ns17
    v_mfma_f32_16x16x32_bf16 v[16:19], v[104:107], v[20:23], v[16:19]
    v_mfma_f32_16x16x32_bf16 v[16:19], v[112:115], v[20:23], v[16:19]
L_b1b_ns17:
    s_waitcnt lgkmcnt(0)
    s_waitcnt vmcnt(0)
    s_barrier
    ds_read_b128 v[96:99], v14 offset:16384
    ds_read_b64_tr_b16 v[104:105], v6 offset:18432
    ds_read_b64_tr_b16 v[106:107], v6 offset:19200
    ds_read_b128 v[100:103], v15 offset:16384
    ds_read_b64_tr_b16 v[112:113], v6 offset:21504
    ds_read_b64_tr_b16 v[114:115], v6 offset:22272
    v_mfma_f32_32x32x16_bf16 v[40:55], v[80:83], v[72:75], v[40:55]
    v_lshlrev_b32 v36, 16, v74
    v_and_b32 v37, 0xffff0000, v74
    v_add_f32 v32, v32, v36
    v_add_f32 v33, v33, v37
    v_fmac_f32 v34, v36, v36
    v_fmac_f32 v35, v37, v37
    v_lshlrev_b32 v38, 16, v75
    v_and_b32 v39, 0xffff0000, v75
    v_add_f32 v32, v32, v38
    v_add_f32 v33, v33, v39
    v_fmac_f32 v34, v38, v38
    v_fmac_f32 v35, v39, v39
    v_mfma_f32_32x32x16_bf16 v[40:55], v[88:91], v[76:79], v[40:55]
    v_lshlrev_b32 v36, 16, v78
    v_and_b32 v37, 0xffff0000, v78
    v_add_f32 v32, v32, v36
    v_add_f32 v33, v33, v37
    v_fmac_f32 v34, v36, v36
    v_fmac_f32 v35, v37, v37
    v_lshlrev_b32 v38, 16, v79
    v_and_b32 v39, 0xffff0000, v79
    v_add_f32 v32, v32, v38
    v_add_f32 v33, v33, v39
    v_fmac_f32 v34, v38, v38
    v_fmac_f32 v35, v39, v39
    s_cbranch_vccz L_b1b_ns18
    v_mfma_f32_16x16x32_bf16 v[16:19], v[80:83], v[20:23], v[16:19]
    v_mfma_f32_16x16x32_bf16 v[16:19], v[88:91], v[20:23], v[16:19]
L_b1b_ns18:
    s_waitcnt lgkmcnt(0)
    v_mfma_f32_32x32x16_bf16 v[40:55], v[104:107], v[96:99], v[40:55]
    v_lshlrev_b32 v36, 16, v98
    v_and_b32 v37, 0xffff0000, v98
    v_add_f32 v32, v32, v36
    v_add_f32 v33, v33, v37
    v_fmac_f32 v34, v36, v36
    v_fmac_f32 v35, v37, v37
    v_lshlrev_b32 v38, 16, v99
    v_and_b32 v39, 0xffff0000, v99
    v_add_f32 v32, v32, v38
    v_add_f32 v33, v33, v39
    v_fmac_f32 v34, v38, v38
    v_fmac_f32 v35, v39, v39
    v_mfma_f32_32x32x16_bf16 v[40:55], v[112:115], v[100:103], v[40:55]
    v_lshlrev_b32 v36, 16, v102
    v_and_b32 v37, 0xffff0000, v102
    v_add_f32 v32, v32, v36
    v_add_f32 v33, v33, v37
    v_fmac_f32 v34, v36, v36
    v_fmac_f32 v35, v37, v37
    v_lshlrev_b32 v38, 16, v103
    v_and_b32 v39, 0xffff0000, v103
    v_add_f32 v32, v32, v38
    v_add_f32 v33, v33, v39
    v_fmac_f32 v34, v38, v38
    v_fmac_f32 v35, v39, v39
    s_cbranch_vccz L_b1b_ns19
    v_mfma_f32_16x16x32_bf16 v[16:19], v[104:107], v[20:23], v[16:19]
    v_mfma_f32_16x16x32_bf16 v[16:19], v[112:115], v[20:23], v[16:19]
L_b1b_ns19:
L_b1_fin:
    s_nop 7
    v_add_f32 v32, v32, v33
    v_add_f32 v33, v34, v35
    v_mov_b32 v24, v32
    v_mov_b32 v25, v32
    s_nop 1
    v_permlane32_swap_b32 v24, v25
    s_nop 1
    v_add_f32 v32, v24, v25
    v_mov_b32 v24, v33
    v_mov_b32 v25, v33
    s_nop 1
    v_permlane32_swap_b32 v24, v25
    s_nop 1
    v_add_f32 v33, v24, v25
    s_lshl_b32 s37, s25, 10
    s_lshl_b32 s38, s24, 8
    s_add_u32 s38, s38, 61440
    s_add_u32 s37, s37, s38
    v_lshl_add_u32 v26, v3, 3, s37
    ds_write_b64 v26, v[32:33]
    s_cmp_lt_u32 s24, 2
    s_cbranch_scc0 L_b1_nocs
    s_lshl_b32 s37, s23, 8
    s_add_u32 s37, s37, 59392
    v_and_b32 v24, 15, v2
    v_lshrrev_b32 v25, 4, v2
    v_lshlrev_b32 v26, 6, v24
    v_lshl_add_u32 v26, v25, 4, v26
    v_add_u32 v26, s37, v26
    v_cmp_gt_u32 vcc, 4, v24
    s_and_saveexec_b64 s[54:55], vcc
    ds_write_b128 v26, v[16:19]
    s_mov_b64 exec, s[54:55]
    v_lshl_add_u32 v26, v3, 2, s37
    s_waitcnt lgkmcnt(0)
    ds_read_b32 v24, v26
    ds_read_b32 v25, v26 offset:128
    s_waitcnt lgkmcnt(0)
    v_add_f32 v36, v24, v25
    s_lshl_b32 s37, s40, 7
    s_add_u32 s37, s37, 58368
    v_lshl_add_u32 v30, v3, 2, s37
    ds_write_b32 v30, v36
    v_lshlrev_b32 v10, 16, v10
    ds_write_b32 v30, v10 offset:512
L_b1_nocs:
    s_waitcnt lgkmcnt(0)
    s_barrier
    s_xor_b32 s37, s25, 1
    s_lshl_b32 s37, s37, 10
    s_add_u32 s37, s37, s38
    v_lshl_add_u32 v26, v3, 3, s37
    ds_read_b64 v[28:29], v26
    s_waitcnt lgkmcnt(0)
    v_add_f32 v32, v32, v28
    v_add_f32 v33, v33, v29
    v_mul_f32 v38, 0x3acccccd, v32
    v_mul_f32 v39, 0x3acccccd, v33
    v_fma_f32 v39, -v38, v38, v39
    v_max_f32 v39, 0, v39
    v_mov_b32 v24, v38
    v_mov_b32 v25, v39
    v_mov_b32 v26, v24
    v_cvt_pk_bf16_f32 v26, v26, v26
    v_and_b32 v26, 0xffff0000, v26
    v_mov_b32 v27, v25
    v_cvt_pk_bf16_f32 v27, v27, v27
    v_and_b32 v27, 0xffff0000, v27
    v_add_f32 v27, 0x3727c5ac, v27
    v_cvt_pk_bf16_f32 v27, v27, v27
    v_and_b32 v27, 0xffff0000, v27
    v_sqrt_f32 v27, v27
    s_nop 0
    v_cvt_pk_bf16_f32 v27, v27, v27
    v_and_b32 v27, 0xffff0000, v27
    v_rcp_f32 v28, v27
    s_nop 0
    v_mul_f32 v29, v26, v28
    v_sub_f32 v30, v24, v26
    v_mul_f32 v30, v30, v28
    v_cvt_pk_bf16_f32 v30, v30, v30
    v_and_b32 v30, 0xffff0000, v30
    v_mul_f32 v31, v25, v28
    v_mul_f32 v31, v31, v28
    v_cvt_pk_bf16_f32 v31, v31, v31
    v_and_b32 v31, 0xffff0000, v31
    v_add_f32 v31, 0x3727c5ac, v31
    v_cvt_pk_bf16_f32 v31, v31, v31
    v_and_b32 v31, 0xffff0000, v31
    v_sqrt_f32 v31, v31
    s_nop 0
    v_cvt_pk_bf16_f32 v31, v31, v31
    v_and_b32 v31, 0xffff0000, v31
    v_rcp_f32 v31, v31
    s_nop 0
    v_add_f32 v29, v29, v30
    v_mul_f32 v29, v29, v31
    v_mul_f32 v28, v28, v31
    s_lshl_b32 s37, s24, 7
    s_add_u32 s37, s37, 57344
    v_lshl_add_u32 v30, v3, 2, s37
    ds_write_b32 v30, v28
    ds_write_b32 v30, v29 offset:512
    s_waitcnt lgkmcnt(0)
    s_cmp_eq_u32 s25, 0
    s_cbranch_scc0 L_b1_e1
    s_lshl_b32 s37, s24, 7
    s_add_u32 s37, s37, 57344
    v_lshl_add_u32 v28, v3, 2, s37
    ds_read_b32 v24, v28
    ds_read_b32 v26, v28 offset:512
    s_lshl_b32 s38, s20, 7
    s_lshl_b32 s39, s24, 5
    s_add_u32 s38, s38, s39
    v_add_u32 v29, s38, v3
    v_and_b32 v33, 1, v2
    v_lshlrev_b32 v30, 3, v29
    v_lshl_add_u32 v30, v1, 14, v30
    v_mul_u32_u24 v31, 32760, v33
    v_add_u32 v30, v30, v31
    s_mov_b32 s50, 0xbdd2d3e8
    s_mov_b32 s51, 0xbdd2d3e8
    v_mov_b32 v12, 0xc0135761
    v_mov_b32 v13, 0xc0135761
    v_lshlrev_b32 v32, 4, v1
    v_add_u32 v32, 58368, v32
    s_lshl_b32 s37, s40, 7
    v_add_u32 v33, s37, v32
    ds_read_b128 v[72:75], v33 offset:0
    ds_read_b128 v[76:79], v33 offset:32
    ds_read_b128 v[80:83], v33 offset:64
    ds_read_b128 v[84:87], v33 offset:96
    ds_read_b128 v[88:91], v33 offset:512
    ds_read_b128 v[92:95], v33 offset:544
    ds_read_b128 v[96:99], v33 offset:576
    ds_read_b128 v[100:103], v33 offset:608
    s_waitcnt lgkmcnt(0)
    v_pk_fma_f32 v[72:73], v[72:73], v[26:27], v[88:89] op_sel_hi:[1,0,1] neg_lo:[0,0,1] neg_hi:[0,0,1]
    v_pk_fma_f32 v[40:41], v[40:41], v[24:25], v[72:73] op_sel_hi:[1,0,1] neg_lo:[0,0,1] neg_hi:[0,0,1]
    v_pk_fma_f32 v[74:75], v[74:75], v[26:27], v[90:91] op_sel_hi:[1,0,1] neg_lo:[0,0,1] neg_hi:[0,0,1]
    v_pk_fma_f32 v[42:43], v[42:43], v[24:25], v[74:75] op_sel_hi:[1,0,1] neg_lo:[0,0,1] neg_hi:[0,0,1]
    v_pk_fma_f32 v[76:77], v[76:77], v[26:27], v[92:93] op_sel_hi:[1,0,1] neg_lo:[0,0,1] neg_hi:[0,0,1]
    v_pk_fma_f32 v[44:45], v[44:45], v[24:25], v[76:77] op_sel_hi:[1,0,1] neg_lo:[0,0,1] neg_hi:[0,0,1]
    v_pk_fma_f32 v[78:79], v[78:79], v[26:27], v[94:95] op_sel_hi:[1,0,1] neg_lo:[0,0,1] neg_hi:[0,0,1]
    v_pk_fma_f32 v[46:47], v[46:47], v[24:25], v[78:79] op_sel_hi:[1,0,1] neg_lo:[0,0,1] neg_hi:[0,0,1]
    v_pk_fma_f32 v[80:81], v[80:81], v[26:27], v[96:97] op_sel_hi:[1,0,1] neg_lo:[0,0,1] neg_hi:[0,0,1]
    v_pk_fma_f32 v[48:49], v[48:49], v[24:25], v[80:81] op_sel_hi:[1,0,1] neg_lo:[0,0,1] neg_hi:[0,0,1]
    v_pk_fma_f32 v[82:83], v[82:83], v[26:27], v[98:99] op_sel_hi:[1,0,1] neg_lo:[0,0,1] neg_hi:[0,0,1]
    v_pk_fma_f32 v[50:51], v[50:51], v[24:25], v[82:83] op_sel_hi:[1,0,1] neg_lo:[0,0,1] neg_hi:[0,0,1]
    v_pk_fma_f32 v[84:85], v[84:85], v[26:27], v[100:101] op_sel_hi:[1,0,1] neg_lo:[0,0,1] neg_hi:[0,0,1]
    v_pk_fma_f32 v[52:53], v[52:53], v[24:25], v[84:85] op_sel_hi:[1,0,1] neg_lo:[0,0,1] neg_hi:[0,0,1]
    v_pk_fma_f32 v[86:87], v[86:87], v[26:27], v[102:103] op_sel_hi:[1,0,1] neg_lo:[0,0,1] neg_hi:[0,0,1]
    v_pk_fma_f32 v[54:55], v[54:55], v[24:25], v[86:87] op_sel_hi:[1,0,1] neg_lo:[0,0,1] neg_hi:[0,0,1]
    v_pk_mul_f32 v[34:35], v[40:41], v[40:41]
    v_pk_fma_f32 v[34:35], v[34:35], s[50:51], v[12:13]
    v_pk_mul_f32 v[34:35], v[34:35], v[40:41]
    v_exp_f32 v34, v34
    v_exp_f32 v35, v35
    s_nop 0
    v_pk_add_f32 v[34:35], v[34:35], 1.0 op_sel_hi:[1,0]
    v_rcp_f32 v34, v34
    v_rcp_f32 v35, v35
    s_nop 0
    v_pk_mul_f32 v[40:41], v[40:41], v[34:35]
    v_pk_mul_f32 v[36:37], v[42:43], v[42:43]
    v_pk_fma_f32 v[36:37], v[36:37], s[50:51], v[12:13]
    v_pk_mul_f32 v[36:37], v[36:37], v[42:43]
    v_exp_f32 v36, v36
    v_exp_f32 v37, v37
    s_nop 0
    v_pk_add_f32 v[36:37], v[36:37], 1.0 op_sel_hi:[1,0]
    v_rcp_f32 v36, v36
    v_rcp_f32 v37, v37
    s_nop 0
    v_pk_mul_f32 v[42:43], v[42:43], v[36:37]
    v_pk_mul_f32 v[34:35], v[44:45], v[44:45]
    v_pk_fma_f32 v[34:35], v[34:35], s[50:51], v[12:13]
    v_pk_mul_f32 v[34:35], v[34:35], v[44:45]
    v_exp_f32 v34, v34
    v_exp_f32 v35, v35
    s_nop 0
    v_pk_add_f32 v[34:35], v[34:35], 1.0 op_sel_hi:[1,0]
    v_rcp_f32 v34, v34
    v_rcp_f32 v35, v35
    s_nop 0
    v_pk_mul_f32 v[44:45], v[44:45], v[34:35]
    v_pk_mul_f32 v[36:37], v[46:47], v[46:47]
    v_pk_fma_f32 v[36:37], v[36:37], s[50:51], v[12:13]
    v_pk_mul_f32 v[36:37], v[36:37], v[46:47]
    v_exp_f32 v36, v36
    v_exp_f32 v37, v37
    s_nop 0
    v_pk_add_f32 v[36:37], v[36:37], 1.0 op_sel_hi:[1,0]
    v_rcp_f32 v36, v36
    v_rcp_f32 v37, v37
    s_nop 0
    v_pk_mul_f32 v[46:47], v[46:47], v[36:37]
    v_pk_mul_f32 v[34:35], v[48:49], v[48:49]
    v_pk_fma_f32 v[34:35], v[34:35], s[50:51], v[12:13]
    v_pk_mul_f32 v[34:35], v[34:35], v[48:49]
    v_exp_f32 v34, v34
    v_exp_f32 v35, v35
    s_nop 0
    v_pk_add_f32 v[34:35], v[34:35], 1.0 op_sel_hi:[1,0]
    v_rcp_f32 v34, v34
    v_rcp_f32 v35, v35
    s_nop 0
    v_pk_mul_f32 v[48:49], v[48:49], v[34:35]
    v_pk_mul_f32 v[36:37], v[50:51], v[50:51]
    v_pk_fma_f32 v[36:37], v[36:37], s[50:51], v[12:13]
    v_pk_mul_f32 v[36:37], v[36:37], v[50:51]
    v_exp_f32 v36, v36
    v_exp_f32 v37, v37
    s_nop 0
    v_pk_add_f32 v[36:37], v[36:37], 1.0 op_sel_hi:[1,0]
    v_rcp_f32 v36, v36
    v_rcp_f32 v37, v37
    s_nop 0
    v_pk_mul_f32 v[50:51], v[50:51], v[36:37]
    v_pk_mul_f32 v[34:35], v[52:53], v[52:53]
    v_pk_fma_f32 v[34:35], v[34:35], s[50:51], v[12:13]
    v_pk_mul_f32 v[34:35], v[34:35], v[52:53]
    v_exp_f32 v34, v34
    v_exp_f32 v35, v35
    s_nop 0
    v_pk_add_f32 v[34:35], v[34:35], 1.0 op_sel_hi:[1,0]
    v_rcp_f32 v34, v34
    v_rcp_f32 v35, v35
    s_nop 0
    v_pk_mul_f32 v[52:53], v[52:53], v[34:35]
    v_pk_mul_f32 v[36:37], v[54:55], v[54:55]
    v_pk_fma_f32 v[36:37], v[36:37], s[50:51], v[12:13]
    v_pk_mul_f32 v[36:37], v[36:37], v[54:55]
    v_exp_f32 v36, v36
    v_exp_f32 v37, v37
    s_nop 0
    v_pk_add_f32 v[36:37], v[36:37], 1.0 op_sel_hi:[1,0]
    v_rcp_f32 v36, v36
    v_rcp_f32 v37, v37
    s_nop 0
    v_pk_mul_f32 v[54:55], v[54:55], v[36:37]
    v_cvt_pk_bf16_f32 v104, v40, v41
    v_cvt_pk_bf16_f32 v105, v42, v43
    v_cvt_pk_bf16_f32 v106, v44, v45
    v_cvt_pk_bf16_f32 v107, v46, v47
    v_cvt_pk_bf16_f32 v108, v48, v49
    v_cvt_pk_bf16_f32 v109, v50, v51
    v_cvt_pk_bf16_f32 v110, v52, v53
    v_cvt_pk_bf16_f32 v111, v54, v55
    s_mov_b32 vcc_lo, 0xaaaaaaaa
    s_mov_b32 vcc_hi, 0xaaaaaaaa
    v_mov_b32_dpp v38, v106 quad_perm:[1,0,3,2] row_mask:0xf bank_mask:0xf
    v_mov_b32_dpp v39, v107 quad_perm:[1,0,3,2] row_mask:0xf bank_mask:0xf
    v_cndmask_b32_dpp v106, v104, v106, vcc quad_perm:[1,0,3,2] row_mask:0xf bank_mask:0xf
    v_cndmask_b32_dpp v107, v105, v107, vcc quad_perm:[1,0,3,2] row_mask:0xf bank_mask:0xf
    v_cndmask_b32 v104, v104, v38, vcc
    v_cndmask_b32 v105, v105, v39, vcc
    v_mov_b32_dpp v38, v110 quad_perm:[1,0,3,2] row_mask:0xf bank_mask:0xf
    v_mov_b32_dpp v39, v111 quad_perm:[1,0,3,2] row_mask:0xf bank_mask:0xf
    v_cndmask_b32_dpp v110, v108, v110, vcc quad_perm:[1,0,3,2] row_mask:0xf bank_mask:0xf
    v_cndmask_b32_dpp v111, v109, v111, vcc quad_perm:[1,0,3,2] row_mask:0xf bank_mask:0xf
    v_cndmask_b32 v108, v108, v38, vcc
    v_cndmask_b32 v109, v109, v39, vcc
    s_lshl_b32 s37, s40, 3
    s_add_u32 s37, s37, s35
    s_lshl_b32 s37, s37, 14
    buffer_store_dwordx4 v[104:107], v30, s[16:19], s37 offen sc1
    s_add_u32 s37, s37, 65536
    buffer_store_dwordx4 v[108:111], v30, s[16:19], s37 offen sc1
    s_nop 1
    s_lshl_b32 s37, s41, 7
    v_add_u32 v33, s37, v32
    ds_read_b128 v[72:75], v33 offset:0
    ds_read_b128 v[76:79], v33 offset:32
    ds_read_b128 v[80:83], v33 offset:64
    ds_read_b128 v[84:87], v33 offset:96
    ds_read_b128 v[88:91], v33 offset:512
    ds_read_b128 v[92:95], v33 offset:544
    ds_read_b128 v[96:99], v33 offset:576
    ds_read_b128 v[100:103], v33 offset:608
    s_waitcnt lgkmcnt(0)
    v_pk_fma_f32 v[72:73], v[72:73], v[26:27], v[88:89] op_sel_hi:[1,0,1] neg_lo:[0,0,1] neg_hi:[0,0,1]
    v_pk_fma_f32 v[56:57], v[56:57], v[24:25], v[72:73] op_sel_hi:[1,0,1] neg_lo:[0,0,1] neg_hi:[0,0,1]
    v_pk_fma_f32 v[74:75], v[74:75], v[26:27], v[90:91] op_sel_hi:[1,0,1] neg_lo:[0,0,1] neg_hi:[0,0,1]
    v_pk_fma_f32 v[58:59], v[58:59], v[24:25], v[74:75] op_sel_hi:[1,0,1] neg_lo:[0,0,1] neg_hi:[0,0,1]
    v_pk_fma_f32 v[76:77], v[76:77], v[26:27], v[92:93] op_sel_hi:[1,0,1] neg_lo:[0,0,1] neg_hi:[0,0,1]
    v_pk_fma_f32 v[60:61], v[60:61], v[24:25], v[76:77] op_sel_hi:[1,0,1] neg_lo:[0,0,1] neg_hi:[0,0,1]
    v_pk_fma_f32 v[78:79], v[78:79], v[26:27], v[94:95] op_sel_hi:[1,0,1] neg_lo:[0,0,1] neg_hi:[0,0,1]
    v_pk_fma_f32 v[62:63], v[62:63], v[24:25], v[78:79] op_sel_hi:[1,0,1] neg_lo:[0,0,1] neg_hi:[0,0,1]
    v_pk_fma_f32 v[80:81], v[80:81], v[26:27], v[96:97] op_sel_hi:[1,0,1] neg_lo:[0,0,1] neg_hi:[0,0,1]
    v_pk_fma_f32 v[64:65], v[64:65], v[24:25], v[80:81] op_sel_hi:[1,0,1] neg_lo:[0,0,1] neg_hi:[0,0,1]
    v_pk_fma_f32 v[82:83], v[82:83], v[26:27], v[98:99] op_sel_hi:[1,0,1] neg_lo:[0,0,1] neg_hi:[0,0,1]
    v_pk_fma_f32 v[66:67], v[66:67], v[24:25], v[82:83] op_sel_hi:[1,0,1] neg_lo:[0,0,1] neg_hi:[0,0,1]
    v_pk_fma_f32 v[84:85], v[84:85], v[26:27], v[100:101] op_sel_hi:[1,0,1] neg_lo:[0,0,1] neg_hi:[0,0,1]
    v_pk_fma_f32 v[68:69], v[68:69], v[24:25], v[84:85] op_sel_hi:[1,0,1] neg_lo:[0,0,1] neg_hi:[0,0,1]
    v_pk_fma_f32 v[86:87], v[86:87], v[26:27], v[102:103] op_sel_hi:[1,0,1] neg_lo:[0,0,1] neg_hi:[0,0,1]
    v_pk_fma_f32 v[70:71], v[70:71], v[24:25], v[86:87] op_sel_hi:[1,0,1] neg_lo:[0,0,1] neg_hi:[0,0,1]
    v_pk_mul_f32 v[34:35], v[56:57], v[56:57]
    v_pk_fma_f32 v[34:35], v[34:35], s[50:51], v[12:13]
    v_pk_mul_f32 v[34:35], v[34:35], v[56:57]
    v_exp_f32 v34, v34
    v_exp_f32 v35, v35
    s_nop 0
    v_pk_add_f32 v[34:35], v[34:35], 1.0 op_sel_hi:[1,0]
    v_rcp_f32 v34, v34
    v_rcp_f32 v35, v35
    s_nop 0
    v_pk_mul_f32 v[56:57], v[56:57], v[34:35]
    v_pk_mul_f32 v[36:37], v[58:59], v[58:59]
    v_pk_fma_f32 v[36:37], v[36:37], s[50:51], v[12:13]
    v_pk_mul_f32 v[36:37], v[36:37], v[58:59]
    v_exp_f32 v36, v36
    v_exp_f32 v37, v37
    s_nop 0
    v_pk_add_f32 v[36:37], v[36:37], 1.0 op_sel_hi:[1,0]
    v_rcp_f32 v36, v36
    v_rcp_f32 v37, v37
    s_nop 0
    v_pk_mul_f32 v[58:59], v[58:59], v[36:37]
    v_pk_mul_f32 v[34:35], v[60:61], v[60:61]
    v_pk_fma_f32 v[34:35], v[34:35], s[50:51], v[12:13]
    v_pk_mul_f32 v[34:35], v[34:35], v[60:61]
    v_exp_f32 v34, v34
    v_exp_f32 v35, v35
    s_nop 0
    v_pk_add_f32 v[34:35], v[34:35], 1.0 op_sel_hi:[1,0]
    v_rcp_f32 v34, v34
    v_rcp_f32 v35, v35
    s_nop 0
    v_pk_mul_f32 v[60:61], v[60:61], v[34:35]
    v_pk_mul_f32 v[36:37], v[62:63], v[62:63]
    v_pk_fma_f32 v[36:37], v[36:37], s[50:51], v[12:13]
    v_pk_mul_f32 v[36:37], v[36:37], v[62:63]
    v_exp_f32 v36, v36
    v_exp_f32 v37, v37
    s_nop 0
    v_pk_add_f32 v[36:37], v[36:37], 1.0 op_sel_hi:[1,0]
    v_rcp_f32 v36, v36
    v_rcp_f32 v37, v37
    s_nop 0
    v_pk_mul_f32 v[62:63], v[62:63], v[36:37]
    v_pk_mul_f32 v[34:35], v[64:65], v[64:65]
    v_pk_fma_f32 v[34:35], v[34:35], s[50:51], v[12:13]
    v_pk_mul_f32 v[34:35], v[34:35], v[64:65]
    v_exp_f32 v34, v34
    v_exp_f32 v35, v35
    s_nop 0
    v_pk_add_f32 v[34:35], v[34:35], 1.0 op_sel_hi:[1,0]
    v_rcp_f32 v34, v34
    v_rcp_f32 v35, v35
    s_nop 0
    v_pk_mul_f32 v[64:65], v[64:65], v[34:35]
    v_pk_mul_f32 v[36:37], v[66:67], v[66:67]
    v_pk_fma_f32 v[36:37], v[36:37], s[50:51], v[12:13]
    v_pk_mul_f32 v[36:37], v[36:37], v[66:67]
    v_exp_f32 v36, v36
    v_exp_f32 v37, v37
    s_nop 0
    v_pk_add_f32 v[36:37], v[36:37], 1.0 op_sel_hi:[1,0]
    v_rcp_f32 v36, v36
    v_rcp_f32 v37, v37
    s_nop 0
    v_pk_mul_f32 v[66:67], v[66:67], v[36:37]
    v_pk_mul_f32 v[34:35], v[68:69], v[68:69]
    v_pk_fma_f32 v[34:35], v[34:35], s[50:51], v[12:13]
    v_pk_mul_f32 v[34:35], v[34:35], v[68:69]
    v_exp_f32 v34, v34
    v_exp_f32 v35, v35
    s_nop 0
    v_pk_add_f32 v[34:35], v[34:35], 1.0 op_sel_hi:[1,0]
    v_rcp_f32 v34, v34
    v_rcp_f32 v35, v35
    s_nop 0
    v_pk_mul_f32 v[68:69], v[68:69], v[34:35]
    v_pk_mul_f32 v[36:37], v[70:71], v[70:71]
    v_pk_fma_f32 v[36:37], v[36:37], s[50:51], v[12:13]
    v_pk_mul_f32 v[36:37], v[36:37], v[70:71]
    v_exp_f32 v36, v36
    v_exp_f32 v37, v37
    s_nop 0
    v_pk_add_f32 v[36:37], v[36:37], 1.0 op_sel_hi:[1,0]
    v_rcp_f32 v36, v36
    v_rcp_f32 v37, v37
    s_nop 0
    v_pk_mul_f32 v[70:71], v[70:71], v[36:37]
    v_cvt_pk_bf16_f32 v104, v56, v57
    v_cvt_pk_bf16_f32 v105, v58, v59
    v_cvt_pk_bf16_f32 v106, v60, v61
    v_cvt_pk_bf16_f32 v107, v62, v63
    v_cvt_pk_bf16_f32 v108, v64, v65
    v_cvt_pk_bf16_f32 v109, v66, v67
    v_cvt_pk_bf16_f32 v110, v68, v69
    v_cvt_pk_bf16_f32 v111, v70, v71
    s_mov_b32 vcc_lo, 0xaaaaaaaa
    s_mov_b32 vcc_hi, 0xaaaaaaaa
    v_mov_b32_dpp v38, v106 quad_perm:[1,0,3,2] row_mask:0xf bank_mask:0xf
    v_mov_b32_dpp v39, v107 quad_perm:[1,0,3,2] row_mask:0xf bank_mask:0xf
    v_cndmask_b32_dpp v106, v104, v106, vcc quad_perm:[1,0,3,2] row_mask:0xf bank_mask:0xf
    v_cndmask_b32_dpp v107, v105, v107, vcc quad_perm:[1,0,3,2] row_mask:0xf bank_mask:0xf
    v_cndmask_b32 v104, v104, v38, vcc
    v_cndmask_b32 v105, v105, v39, vcc
    v_mov_b32_dpp v38, v110 quad_perm:[1,0,3,2] row_mask:0xf bank_mask:0xf
    v_mov_b32_dpp v39, v111 quad_perm:[1,0,3,2] row_mask:0xf bank_mask:0xf
    v_cndmask_b32_dpp v110, v108, v110, vcc quad_perm:[1,0,3,2] row_mask:0xf bank_mask:0xf
    v_cndmask_b32_dpp v111, v109, v111, vcc quad_perm:[1,0,3,2] row_mask:0xf bank_mask:0xf
    v_cndmask_b32 v108, v108, v38, vcc
    v_cndmask_b32 v109, v109, v39, vcc
    s_lshl_b32 s37, s41, 3
    s_add_u32 s37, s37, s35
    s_lshl_b32 s37, s37, 14
    buffer_store_dwordx4 v[104:107], v30, s[16:19], s37 offen sc1
    s_add_u32 s37, s37, 65536
    buffer_store_dwordx4 v[108:111], v30, s[16:19], s37 offen sc1
    s_nop 1
    s_branch L_b1_pub
L_b1_e1:
    s_lshl_b32 s37, s24, 7
    s_add_u32 s37, s37, 57344
    v_lshl_add_u32 v28, v3, 2, s37
    ds_read_b32 v24, v28
    ds_read_b32 v26, v28 offset:512
    s_lshl_b32 s38, s20, 7
    s_lshl_b32 s39, s24, 5
    s_add_u32 s38, s38, s39
    v_add_u32 v29, s38, v3
    v_and_b32 v33, 1, v2
    v_lshlrev_b32 v30, 3, v29
    v_lshl_add_u32 v30, v1, 14, v30
    v_mul_u32_u24 v31, 32760, v33
    v_add_u32 v30, v30, v31
    s_mov_b32 s50, 0xbdd2d3e8
    s_mov_b32 s51, 0xbdd2d3e8
    v_mov_b32 v12, 0xc0135761
    v_mov_b32 v13, 0xc0135761
    v_lshlrev_b32 v32, 4, v1
    v_add_u32 v32, 58368, v32
    s_lshl_b32 s37, s40, 7
    v_add_u32 v33, s37, v32
    ds_read_b128 v[72:75], v33 offset:0
    ds_read_b128 v[76:79], v33 offset:32
    ds_read_b128 v[80:83], v33 offset:64
    ds_read_b128 v[84:87], v33 offset:96
    ds_read_b128 v[88:91], v33 offset:512
    ds_read_b128 v[92:95], v33 offset:544
    ds_read_b128 v[96:99], v33 offset:576
    ds_read_b128 v[100:103], v33 offset:608
    s_waitcnt lgkmcnt(0)
    v_pk_fma_f32 v[72:73], v[72:73], v[26:27], v[88:89] op_sel_hi:[1,0,1] neg_lo:[0,0,1] neg_hi:[0,0,1]
    v_pk_fma_f32 v[40:41], v[40:41], v[24:25], v[72:73] op_sel_hi:[1,0,1] neg_lo:[0,0,1] neg_hi:[0,0,1]
    v_pk_fma_f32 v[74:75], v[74:75], v[26:27], v[90:91] op_sel_hi:[1,0,1] neg_lo:[0,0,1] neg_hi:[0,0,1]
    v_pk_fma_f32 v[42:43], v[42:43], v[24:25], v[74:75] op_sel_hi:[1,0,1] neg_lo:[0,0,1] neg_hi:[0,0,1]
    v_pk_fma_f32 v[76:77], v[76:77], v[26:27], v[92:93] op_sel_hi:[1,0,1] neg_lo:[0,0,1] neg_hi:[0,0,1]
    v_pk_fma_f32 v[44:45], v[44:45], v[24:25], v[76:77] op_sel_hi:[1,0,1] neg_lo:[0,0,1] neg_hi:[0,0,1]
    v_pk_fma_f32 v[78:79], v[78:79], v[26:27], v[94:95] op_sel_hi:[1,0,1] neg_lo:[0,0,1] neg_hi:[0,0,1]
    v_pk_fma_f32 v[46:47], v[46:47], v[24:25], v[78:79] op_sel_hi:[1,0,1] neg_lo:[0,0,1] neg_hi:[0,0,1]
    v_pk_fma_f32 v[80:81], v[80:81], v[26:27], v[96:97] op_sel_hi:[1,0,1] neg_lo:[0,0,1] neg_hi:[0,0,1]
    v_pk_fma_f32 v[48:49], v[48:49], v[24:25], v[80:81] op_sel_hi:[1,0,1] neg_lo:[0,0,1] neg_hi:[0,0,1]
    v_pk_fma_f32 v[82:83], v[82:83], v[26:27], v[98:99] op_sel_hi:[1,0,1] neg_lo:[0,0,1] neg_hi:[0,0,1]
    v_pk_fma_f32 v[50:51], v[50:51], v[24:25], v[82:83] op_sel_hi:[1,0,1] neg_lo:[0,0,1] neg_hi:[0,0,1]
    v_pk_fma_f32 v[84:85], v[84:85], v[26:27], v[100:101] op_sel_hi:[1,0,1] neg_lo:[0,0,1] neg_hi:[0,0,1]
    v_pk_fma_f32 v[52:53], v[52:53], v[24:25], v[84:85] op_sel_hi:[1,0,1] neg_lo:[0,0,1] neg_hi:[0,0,1]
    v_pk_fma_f32 v[86:87], v[86:87], v[26:27], v[102:103] op_sel_hi:[1,0,1] neg_lo:[0,0,1] neg_hi:[0,0,1]
    v_pk_fma_f32 v[54:55], v[54:55], v[24:25], v[86:87] op_sel_hi:[1,0,1] neg_lo:[0,0,1] neg_hi:[0,0,1]
    v_pk_mul_f32 v[34:35], v[40:41], v[40:41]
    v_pk_fma_f32 v[34:35], v[34:35], s[50:51], v[12:13]
    v_pk_mul_f32 v[34:35], v[34:35], v[40:41]
    v_exp_f32 v34, v34
    v_exp_f32 v35, v35
    s_nop 0
    v_pk_add_f32 v[34:35], v[34:35], 1.0 op_sel_hi:[1,0]
    v_rcp_f32 v34, v34
    v_rcp_f32 v35, v35
    s_nop 0
    v_pk_mul_f32 v[40:41], v[40:41], v[34:35]
    v_pk_mul_f32 v[36:37], v[42:43], v[42:43]
    v_pk_fma_f32 v[36:37], v[36:37], s[50:51], v[12:13]
    v_pk_mul_f32 v[36:37], v[36:37], v[42:43]
    v_exp_f32 v36, v36
    v_exp_f32 v37, v37
    s_nop 0
    v_pk_add_f32 v[36:37], v[36:37], 1.0 op_sel_hi:[1,0]
    v_rcp_f32 v36, v36
    v_rcp_f32 v37, v37
    s_nop 0
    v_pk_mul_f32 v[42:43], v[42:43], v[36:37]
    v_pk_mul_f32 v[34:35], v[44:45], v[44:45]
    v_pk_fma_f32 v[34:35], v[34:35], s[50:51], v[12:13]
    v_pk_mul_f32 v[34:35], v[34:35], v[44:45]
    v_exp_f32 v34, v34
    v_exp_f32 v35, v35
    s_nop 0
    v_pk_add_f32 v[34:35], v[34:35], 1.0 op_sel_hi:[1,0]
    v_rcp_f32 v34, v34
    v_rcp_f32 v35, v35
    s_nop 0
    v_pk_mul_f32 v[44:45], v[44:45], v[34:35]
    v_pk_mul_f32 v[36:37], v[46:47], v[46:47]
    v_pk_fma_f32 v[36:37], v[36:37], s[50:51], v[12:13]
    v_pk_mul_f32 v[36:37], v[36:37], v[46:47]
    v_exp_f32 v36, v36
    v_exp_f32 v37, v37
    s_nop 0
    v_pk_add_f32 v[36:37], v[36:37], 1.0 op_sel_hi:[1,0]
    v_rcp_f32 v36, v36
    v_rcp_f32 v37, v37
    s_nop 0
    v_pk_mul_f32 v[46:47], v[46:47], v[36:37]
    v_pk_mul_f32 v[34:35], v[48:49], v[48:49]
    v_pk_fma_f32 v[34:35], v[34:35], s[50:51], v[12:13]
    v_pk_mul_f32 v[34:35], v[34:35], v[48:49]
    v_exp_f32 v34, v34
    v_exp_f32 v35, v35
    s_nop 0
    v_pk_add_f32 v[34:35], v[34:35], 1.0 op_sel_hi:[1,0]
    v_rcp_f32 v34, v34
    v_rcp_f32 v35, v35
    s_nop 0
    v_pk_mul_f32 v[48:49], v[48:49], v[34:35]
    v_pk_mul_f32 v[36:37], v[50:51], v[50:51]
    v_pk_fma_f32 v[36:37], v[36:37], s[50:51], v[12:13]
    v_pk_mul_f32 v[36:37], v[36:37], v[50:51]
    v_exp_f32 v36, v36
    v_exp_f32 v37, v37
    s_nop 0
    v_pk_add_f32 v[36:37], v[36:37], 1.0 op_sel_hi:[1,0]
    v_rcp_f32 v36, v36
    v_rcp_f32 v37, v37
    s_nop 0
    v_pk_mul_f32 v[50:51], v[50:51], v[36:37]
    v_pk_mul_f32 v[34:35], v[52:53], v[52:53]
    v_pk_fma_f32 v[34:35], v[34:35], s[50:51], v[12:13]
    v_pk_mul_f32 v[34:35], v[34:35], v[52:53]
    v_exp_f32 v34, v34
    v_exp_f32 v35, v35
    s_nop 0
    v_pk_add_f32 v[34:35], v[34:35], 1.0 op_sel_hi:[1,0]
    v_rcp_f32 v34, v34
    v_rcp_f32 v35, v35
    s_nop 0
    v_pk_mul_f32 v[52:53], v[52:53], v[34:35]
    v_pk_mul_f32 v[36:37], v[54:55], v[54:55]
    v_pk_fma_f32 v[36:37], v[36:37], s[50:51], v[12:13]
    v_pk_mul_f32 v[36:37], v[36:37], v[54:55]
    v_exp_f32 v36, v36
    v_exp_f32 v37, v37
    s_nop 0
    v_pk_add_f32 v[36:37], v[36:37], 1.0 op_sel_hi:[1,0]
    v_rcp_f32 v36, v36
    v_rcp_f32 v37, v37
    s_nop 0
    v_pk_mul_f32 v[54:55], v[54:55], v[36:37]
    v_cvt_pk_bf16_f32 v104, v40, v41
    v_cvt_pk_bf16_f32 v105, v42, v43
    v_cvt_pk_bf16_f32 v106, v44, v45
    v_cvt_pk_bf16_f32 v107, v46, v47
    v_cvt_pk_bf16_f32 v108, v48, v49
    v_cvt_pk_bf16_f32 v109, v50, v51
    v_cvt_pk_bf16_f32 v110, v52, v53
    v_cvt_pk_bf16_f32 v111, v54, v55
    s_mov_b32 vcc_lo, 0xaaaaaaaa
    s_mov_b32 vcc_hi, 0xaaaaaaaa
    v_mov_b32_dpp v38, v106 quad_perm:[1,0,3,2] row_mask:0xf bank_mask:0xf
    v_mov_b32_dpp v39, v107 quad_perm:[1,0,3,2] row_mask:0xf bank_mask:0xf
    v_cndmask_b32_dpp v106, v104, v106, vcc quad_perm:[1,0,3,2] row_mask:0xf bank_mask:0xf
    v_cndmask_b32_dpp v107, v105, v107, vcc quad_perm:[1,0,3,2] row_mask:0xf bank_mask:0xf
    v_cndmask_b32 v104, v104, v38, vcc
    v_cndmask_b32 v105, v105, v39, vcc
    v_mov_b32_dpp v38, v110 quad_perm:[1,0,3,2] row_mask:0xf bank_mask:0xf
    v_mov_b32_dpp v39, v111 quad_perm:[1,0,3,2] row_mask:0xf bank_mask:0xf
    v_cndmask_b32_dpp v110, v108, v110, vcc quad_perm:[1,0,3,2] row_mask:0xf bank_mask:0xf
    v_cndmask_b32_dpp v111, v109, v111, vcc quad_perm:[1,0,3,2] row_mask:0xf bank_mask:0xf
    v_cndmask_b32 v108, v108, v38, vcc
    v_cndmask_b32 v109, v109, v39, vcc
    s_lshl_b32 s37, s40, 3
    s_add_u32 s37, s37, s35
    s_lshl_b32 s37, s37, 14
    buffer_store_dwordx4 v[104:107], v30, s[16:19], s37 offen sc1
    s_add_u32 s37, s37, 65536
    buffer_store_dwordx4 v[108:111], v30, s[16:19], s37 offen sc1
    s_nop 1
L_b1_pub:
    s_waitcnt vmcnt(0) lgkmcnt(0)
    s_barrier
    s_cmp_lg_u32 s23, 0
    s_cbranch_scc1 L_b1_nof
    s_memrealtime s[82:83]
    s_lshl_b32 s36, s20, 4
    s_add_u32 s36, s36, s21
    s_lshl_b32 s36, s36, 7
    s_add_u32 s36, s36, 21528576
    v_mov_b32 v10, s36
    s_waitcnt lgkmcnt(0)
    v_mov_b32 v12, s82
    v_xor_b32 v13, 0x5bd1e995, v12
    s_mov_b64 s[88:89], exec
    s_mov_b64 exec, 1
    global_store_dwordx2 v10, v[12:13], s[4:5] sc1
    s_mov_b64 exec, s[88:89]
L_b1_nof:
L_mb_m2:
    s_and_b32 s20, s3, 7
    s_lshl_b32 s20, s20, 2
    s_bfe_u32 s21, s3, 0x20003
    s_add_u32 s20, s20, s21
    s_lshr_b32 s21, s3, 5
    v_lshrrev_b32 v10, 6, v0
    v_and_b32 v2, 63, v0
    s_nop 0
    v_readfirstlane_b32 s23, v10
    v_and_b32 v3, 15, v2
    v_lshrrev_b32 v1, 4, v2
    s_and_b32 s24, s23, 1
    s_lshr_b32 s25, s23, 1
    s_add_u32 s37, s23, 0
    s_min_u32 s37, s37, 19
    s_lshl_b32 s28, s37, 10
    v_lshl_add_u32 v10, v2, 4, s28
    v_lshrrev_b32 v11, 5, v10
    v_mul_u32_u24 v11, 13108, v11
    v_lshrrev_b32 v11, 16, v11
    v_mul_u32_u24 v12, 160, v11
    v_sub_u32 v12, v10, v12
    v_mul_u32_u24 v11, 1280, v11
    s_mul_i32 s37, s21, 160
    v_add3_u32 v4, v11, v12, s37
    s_add_u32 s37, s23, 8
    s_min_u32 s37, s37, 19
    s_lshl_b32 s29, s37, 10
    v_lshl_add_u32 v10, v2, 4, s29
    v_lshrrev_b32 v11, 5, v10
    v_mul_u32_u24 v11, 13108, v11
    v_lshrrev_b32 v11, 16, v11
    v_mul_u32_u24 v12, 160, v11
    v_sub_u32 v12, v10, v12
    v_mul_u32_u24 v11, 1280, v11
    s_mul_i32 s37, s21, 160
    v_add3_u32 v5, v11, v12, s37
    s_add_u32 s37, s23, 16
    s_min_u32 s37, s37, 19
    s_lshl_b32 s30, s37, 10
    v_lshl_add_u32 v10, v2, 4, s30
    v_lshrrev_b32 v11, 5, v10
    v_mul_u32_u24 v11, 13108, v11
    v_lshrrev_b32 v11, 16, v11
    v_mul_u32_u24 v12, 160, v11
    v_sub_u32 v12, v10, v12
    v_mul_u32_u24 v11, 1280, v11
    s_mul_i32 s37, s21, 160
    v_add3_u32 v6, v11, v12, s37
    s_lshl_b32 s37, s25, 3
    v_add_u32 v10, s37, v1
    v_lshlrev_b32 v10, 14, v10
    s_lshl_b32 s37, s20, 6
    s_lshl_b32 s38, s24, 5
    s_add_u32 s37, s37, s38
    v_add_u32 v11, s37, v3
    v_lshl_add_u32 v7, v11, 3, v10
    v_bfe_u32 v10, v2, 2, 2
    v_lshl_add_u32 v10, v1, 2, v10
    s_lshl_b32 s37, s25, 5
    v_add_u32 v10, s37, v10
    v_mul_u32_u24 v10, 160, v10
    v_and_b32 v11, 3, v2
    v_lshl_add_u32 v8, v11, 3, v10
    s_mul_i32 s37, s25, 20480
    s_mul_i32 s38, s24, 10240
    s_add_u32 s37, s37, s38
    v_bfe_u32 v10, v3, 1, 2
    v_xor_b32 v10, v10, v1
    v_mul_u32_u24 v11, 320, v3
    v_lshl_add_u32 v10, v10, 4, v11
    v_add_u32 v9, s37, v10
    s_load_dwordx4 s[56:59], s[0:1], 48
    s_load_dwordx2 s[60:61], s[0:1], 16
    s_load_dwordx2 s[62:63], s[0:1], 0
    s_load_dwordx4 s[64:67], s[0:1], 64
    s_waitcnt lgkmcnt(0)
    s_add_u32 s8, s4, 9437184
    s_addc_u32 s9, s5, 0
    s_mov_b32 s10, 6291456
    s_mov_b32 s11, 0x00020000
    s_add_u32 s12, s56, 0
    s_addc_u32 s13, s57, 0
    s_mov_b32 s14, 1966080
    s_mov_b32 s15, 0x00020000
    s_add_u32 s16, s64, 0
    s_addc_u32 s17, s65, 0
    s_mov_b32 s18, 2621440
    s_mov_b32 s19, 0x00020000
    s_add_u32 s44, s58, 0
    s_addc_u32 s45, s59, 0
    s_mov_b32 s46, 1280
    s_mov_b32 s47, 0x00020000
    s_add_u32 s48, s62, 0
    s_addc_u32 s49, s63, 0
    s_mov_b32 s50, 2621440
    s_mov_b32 s51, 0x00020000
    s_add_u32 s52, s60, 0
    s_addc_u32 s53, s61, 0
    s_mov_b32 s54, 819200
    s_mov_b32 s55, 0x00020000
    s_add_u32 s68, s4, 15728640
    s_addc_u32 s69, s5, 0
    s_mov_b32 s70, 2621440
    s_mov_b32 s71, 0x00020000
    s_cmp_lg_u32 s23, 0
    s_cbranch_scc1 L_mbh_wd
    s_mov_b32 s95, 0
    s_lshr_b32 s37, s20, 1
    s_lshl_b32 s37, s37, 11
    s_add_u32 s37, s37, 21528576
    v_and_b32 v10, 15, v2
    v_lshl_add_u32 v10, v10, 7, s37
    s_mov_b32 s38, 0
L_mbh_poll:
    global_load_dwordx2 v[12:13], v10, s[4:5] sc1
    s_waitcnt vmcnt(0)
    v_subrev_u32 v11, s90, v12
    v_add_u32 v11, -1, v11
    v_xor_b32 v13, v13, v12
    v_xor_b32 v13, 0x5bd1e995, v13
    v_lshrrev_b32 v11, 24, v11
    v_or_b32 v11, v11, v13
    v_cmp_ne_u32 vcc, 0, v11
    s_nop 3
    s_cmp_eq_u64 vcc, 0
    s_cbranch_scc1 L_mbh_pok
    s_sleep 5
    s_add_u32 s38, s38, 1
    s_cmp_lt_u32 s38, 400
    s_cbranch_scc1 L_mbh_poll
    s_ff1_i32_b64 s39, vcc
    s_add_u32 s95, s39, 1
L_mbh_pok:
    v_mov_b32 v10, 61440
    v_mov_b32 v11, s95
    ds_write_b32 v10, v11
L_mbh_wd:
    s_waitcnt vmcnt(0) lgkmcnt(0)
    s_barrier
    v_mov_b32 v10, 61440
    ds_read_b32 v11, v10
    s_waitcnt lgkmcnt(0)
    v_readfirstlane_b32 s95, v11
    s_nop 3
    s_cmp_eq_u32 s95, 0
    s_cbranch_scc1 L_mb_m2go
    s_barrier
    s_lshr_b32 s20, s20, 1
    s_sub_u32 s21, s95, 1
    s_branch L_b1_task
L_mb_m2go:
    s_setprio 0
    s_cmp_ge_u32 s23, 4
    s_cbranch_scc1 L_mb_hi
    s_mov_b32 s42, 0
    s_mov_b32 s43, 0
    s_mov_b32 s41, 0
    s_add_u32 s35, s42, 65536
    buffer_load_dwordx2 v[60:61], v7, s[8:11], s42 offen
    buffer_load_dwordx2 v[62:63], v7, s[8:11], s35 offen
    buffer_load_dwordx2 v[64:65], v7, s[8:11], s42 offen offset:128
    buffer_load_dwordx2 v[66:67], v7, s[8:11], s35 offen offset:128
    s_add_u32 s42, s42, 524288
    s_add_u32 m0, s28, 0
    s_nop 0
    buffer_load_dwordx4 v4, s[12:15], s43 offen lds
    s_add_u32 m0, s29, 0
    s_nop 0
    buffer_load_dwordx4 v5, s[12:15], s43 offen lds
    s_add_u32 m0, s30, 0
    s_nop 0
    buffer_load_dwordx4 v6, s[12:15], s43 offen lds
    s_add_u32 s43, s43, 163840
    s_add_u32 s35, s42, 65536
    buffer_load_dwordx2 v[68:69], v7, s[8:11], s42 offen
    buffer_load_dwordx2 v[70:71], v7, s[8:11], s35 offen
    buffer_load_dwordx2 v[72:73], v7, s[8:11], s42 offen offset:128
    buffer_load_dwordx2 v[74:75], v7, s[8:11], s35 offen offset:128
    s_add_u32 s42, s42, 524288
    s_add_u32 m0, s28, 20480
    s_nop 0
    buffer_load_dwordx4 v4, s[12:15], s43 offen lds
    s_add_u32 m0, s29, 20480
    s_nop 0
    buffer_load_dwordx4 v5, s[12:15], s43 offen lds
    s_add_u32 m0, s30, 20480
    s_nop 0
    buffer_load_dwordx4 v6, s[12:15], s43 offen lds
    s_add_u32 s43, s43, 163840
    s_add_u32 s35, s42, 65536
    buffer_load_dwordx2 v[76:77], v7, s[8:11], s42 offen
    buffer_load_dwordx2 v[78:79], v7, s[8:11], s35 offen
    buffer_load_dwordx2 v[80:81], v7, s[8:11], s42 offen offset:128
    buffer_load_dwordx2 v[82:83], v7, s[8:11], s35 offen offset:128
    s_add_u32 s42, s42, 524288
    s_add_u32 m0, s28, 40960
    s_nop 0
    buffer_load_dwordx4 v4, s[12:15], s43 offen lds
    s_add_u32 m0, s29, 40960
    s_nop 0
    buffer_load_dwordx4 v5, s[12:15], s43 offen lds
    s_add_u32 m0, s30, 40960
    s_nop 0
    buffer_load_dwordx4 v6, s[12:15], s43 offen lds
    s_add_u32 s43, s43, 163840
    v_mov_b32 v20, 0
    v_mov_b32 v21, 0
    v_mov_b32 v22, 0
    v_mov_b32 v23, 0
    v_mov_b32 v24, 0
    v_mov_b32 v25, 0
    v_mov_b32 v26, 0
    v_mov_b32 v27, 0
    v_mov_b32 v28, 0
    v_mov_b32 v29, 0
    v_mov_b32 v30, 0
    v_mov_b32 v31, 0
    v_mov_b32 v32, 0
    v_mov_b32 v33, 0
    v_mov_b32 v34, 0
    v_mov_b32 v35, 0
    v_mov_b32 v36, 0
    v_mov_b32 v37, 0
    v_mov_b32 v38, 0
    v_mov_b32 v39, 0
    v_mov_b32 v40, 0
    v_mov_b32 v41, 0
    v_mov_b32 v42, 0
    v_mov_b32 v43, 0
    v_mov_b32 v44, 0
    v_mov_b32 v45, 0
    v_mov_b32 v46, 0
    v_mov_b32 v47, 0
    v_mov_b32 v48, 0
    v_mov_b32 v49, 0
    v_mov_b32 v50, 0
    v_mov_b32 v51, 0
    v_mov_b32 v52, 0
    v_mov_b32 v53, 0
    v_mov_b32 v54, 0
    v_mov_b32 v55, 0
    v_mov_b32 v56, 0
    v_mov_b32 v57, 0
    v_mov_b32 v58, 0
    v_mov_b32 v59, 0
    s_waitcnt vmcnt(14)
    s_barrier
    ds_read_b64_tr_b16 v[100:101], v8 offset:0
    ds_read_b64_tr_b16 v[102:103], v8 offset:2560
    ds_read_b64_tr_b16 v[104:105], v8 offset:32
    ds_read_b64_tr_b16 v[106:107], v8 offset:2592
    ds_read_b64_tr_b16 v[108:109], v8 offset:64
    ds_read_b64_tr_b16 v[110:111], v8 offset:2624
    ds_read_b64_tr_b16 v[112:113], v8 offset:96
    ds_read_b64_tr_b16 v[114:115], v8 offset:2656
    ds_read_b64_tr_b16 v[116:117], v8 offset:128
    ds_read_b64_tr_b16 v[118:119], v8 offset:2688
L_mb_lplo:
    s_waitcnt lgkmcnt(0)
    v_mfma_f32_16x16x32_bf16 v[20:23], v[100:103], v[60:63], v[20:23]
    v_mfma_f32_16x16x32_bf16 v[24:27], v[100:103], v[64:67], v[24:27]
    v_mfma_f32_16x16x32_bf16 v[28:31], v[104:107], v[60:63], v[28:31]
    v_mfma_f32_16x16x32_bf16 v[32:35], v[104:107], v[64:67], v[32:35]
    v_mfma_f32_16x16x32_bf16 v[36:39], v[108:111], v[60:63], v[36:39]
    v_mfma_f32_16x16x32_bf16 v[40:43], v[108:111], v[64:67], v[40:43]
    v_mfma_f32_16x16x32_bf16 v[44:47], v[112:115], v[60:63], v[44:47]
    v_mfma_f32_16x16x32_bf16 v[48:51], v[112:115], v[64:67], v[48:51]
    v_mfma_f32_16x16x32_bf16 v[52:55], v[116:119], v[60:63], v[52:55]
    v_mfma_f32_16x16x32_bf16 v[56:59], v[116:119], v[64:67], v[56:59]
    s_waitcnt vmcnt(7)
    s_barrier
    s_add_u32 s35, s42, 65536
    buffer_load_dwordx2 v[60:61], v7, s[8:11], s42 offen
    buffer_load_dwordx2 v[62:63], v7, s[8:11], s35 offen
    buffer_load_dwordx2 v[64:65], v7, s[8:11], s42 offen offset:128
    buffer_load_dwordx2 v[66:67], v7, s[8:11], s35 offen offset:128
    s_add_u32 s42, s42, 524288
    s_add_u32 m0, s28, 0
    s_nop 0
    buffer_load_dwordx4 v4, s[12:15], s43 offen lds
    s_add_u32 m0, s29, 0
    s_nop 0
    buffer_load_dwordx4 v5, s[12:15], s43 offen lds
    s_add_u32 m0, s30, 0
    s_nop 0
    buffer_load_dwordx4 v6, s[12:15], s43 offen lds
    s_add_u32 s43, s43, 163840
    ds_read_b64_tr_b16 v[100:101], v8 offset:20480
    ds_read_b64_tr_b16 v[102:103], v8 offset:23040
    ds_read_b64_tr_b16 v[104:105], v8 offset:20512
    ds_read_b64_tr_b16 v[106:107], v8 offset:23072
    ds_read_b64_tr_b16 v[108:109], v8 offset:20544
    ds_read_b64_tr_b16 v[110:111], v8 offset:23104
    ds_read_b64_tr_b16 v[112:113], v8 offset:20576
    ds_read_b64_tr_b16 v[114:115], v8 offset:23136
    ds_read_b64_tr_b16 v[116:117], v8 offset:20608
    ds_read_b64_tr_b16 v[118:119], v8 offset:23168
    s_waitcnt lgkmcnt(0)
    v_mfma_f32_16x16x32_bf16 v[20:23], v[100:103], v[68:71], v[20:23]
    v_mfma_f32_16x16x32_bf16 v[24:27], v[100:103], v[72:75], v[24:27]
    v_mfma_f32_16x16x32_bf16 v[28:31], v[104:107], v[68:71], v[28:31]
    v_mfma_f32_16x16x32_bf16 v[32:35], v[104:107], v[72:75], v[32:35]
    v_mfma_f32_16x16x32_bf16 v[36:39], v[108:111], v[68:71], v[36:39]
    v_mfma_f32_16x16x32_bf16 v[40:43], v[108:111], v[72:75], v[40:43]
    v_mfma_f32_16x16x32_bf16 v[44:47], v[112:115], v[68:71], v[44:47]
    v_mfma_f32_16x16x32_bf16 v[48:51], v[112:115], v[72:75], v[48:51]
    v_mfma_f32_16x16x32_bf16 v[52:55], v[116:119], v[68:71], v[52:55]
    v_mfma_f32_16x16x32_bf16 v[56:59], v[116:119], v[72:75], v[56:59]
    s_waitcnt vmcnt(7)
    s_barrier
    s_add_u32 s35, s42, 65536
    buffer_load_dwordx2 v[68:69], v7, s[8:11], s42 offen
    buffer_load_dwordx2 v[70:71], v7, s[8:11], s35 offen
    buffer_load_dwordx2 v[72:73], v7, s[8:11], s42 offen offset:128
    buffer_load_dwordx2 v[74:75], v7, s[8:11], s35 offen offset:128
    s_add_u32 s42, s42, 524288
    s_add_u32 m0, s28, 20480
    s_nop 0
    buffer_load_dwordx4 v4, s[12:15], s43 offen lds
    s_add_u32 m0, s29, 20480
    s_nop 0
    buffer_load_dwordx4 v5, s[12:15], s43 offen lds
    s_add_u32 m0, s30, 20480
    s_nop 0
    buffer_load_dwordx4 v6, s[12:15], s43 offen lds
    s_add_u32 s43, s43, 163840
    ds_read_b64_tr_b16 v[100:101], v8 offset:40960
    ds_read_b64_tr_b16 v[102:103], v8 offset:43520
    ds_read_b64_tr_b16 v[104:105], v8 offset:40992
    ds_read_b64_tr_b16 v[106:107], v8 offset:43552
    ds_read_b64_tr_b16 v[108:109], v8 offset:41024
    ds_read_b64_tr_b16 v[110:111], v8 offset:43584
    ds_read_b64_tr_b16 v[112:113], v8 offset:41056
    ds_read_b64_tr_b16 v[114:115], v8 offset:43616
    ds_read_b64_tr_b16 v[116:117], v8 offset:41088
    ds_read_b64_tr_b16 v[118:119], v8 offset:43648
    s_waitcnt lgkmcnt(0)
    v_mfma_f32_16x16x32_bf16 v[20:23], v[100:103], v[76:79], v[20:23]
    v_mfma_f32_16x16x32_bf16 v[24:27], v[100:103], v[80:83], v[24:27]
    v_mfma_f32_16x16x32_bf16 v[28:31], v[104:107], v[76:79], v[28:31]
    v_mfma_f32_16x16x32_bf16 v[32:35], v[104:107], v[80:83], v[32:35]
    v_mfma_f32_16x16x32_bf16 v[36:39], v[108:111], v[76:79], v[36:39]
    v_mfma_f32_16x16x32_bf16 v[40:43], v[108:111], v[80:83], v[40:43]
    v_mfma_f32_16x16x32_bf16 v[44:47], v[112:115], v[76:79], v[44:47]
    v_mfma_f32_16x16x32_bf16 v[48:51], v[112:115], v[80:83], v[48:51]
    v_mfma_f32_16x16x32_bf16 v[52:55], v[116:119], v[76:79], v[52:55]
    v_mfma_f32_16x16x32_bf16 v[56:59], v[116:119], v[80:83], v[56:59]
    s_waitcnt vmcnt(7)
    s_barrier
    s_add_u32 s35, s42, 65536
    buffer_load_dwordx2 v[76:77], v7, s[8:11], s42 offen
    buffer_load_dwordx2 v[78:79], v7, s[8:11], s35 offen
    buffer_load_dwordx2 v[80:81], v7, s[8:11], s42 offen offset:128
    buffer_load_dwordx2 v[82:83], v7, s[8:11], s35 offen offset:128
    s_add_u32 s42, s42, 524288
    s_add_u32 m0, s28, 40960
    s_nop 0
    buffer_load_dwordx4 v4, s[12:15], s43 offen lds
    s_add_u32 m0, s29, 40960
    s_nop 0
    buffer_load_dwordx4 v5, s[12:15], s43 offen lds
    s_add_u32 m0, s30, 40960
    s_nop 0
    buffer_load_dwordx4 v6, s[12:15], s43 offen lds
    s_add_u32 s43, s43, 163840
    ds_read_b64_tr_b16 v[100:101], v8 offset:0
    ds_read_b64_tr_b16 v[102:103], v8 offset:2560
    ds_read_b64_tr_b16 v[104:105], v8 offset:32
    ds_read_b64_tr_b16 v[106:107], v8 offset:2592
    ds_read_b64_tr_b16 v[108:109], v8 offset:64
    ds_read_b64_tr_b16 v[110:111], v8 offset:2624
    ds_read_b64_tr_b16 v[112:113], v8 offset:96
    ds_read_b64_tr_b16 v[114:115], v8 offset:2656
    ds_read_b64_tr_b16 v[116:117], v8 offset:128
    ds_read_b64_tr_b16 v[118:119], v8 offset:2688
    s_add_u32 s41, s41, 1
    s_cmp_lt_u32 s41, 3
    s_cbranch_scc1 L_mb_lplo
    s_waitcnt lgkmcnt(0)
    v_mfma_f32_16x16x32_bf16 v[20:23], v[100:103], v[60:63], v[20:23]
    v_mfma_f32_16x16x32_bf16 v[24:27], v[100:103], v[64:67], v[24:27]
    v_mfma_f32_16x16x32_bf16 v[28:31], v[104:107], v[60:63], v[28:31]
    v_mfma_f32_16x16x32_bf16 v[32:35], v[104:107], v[64:67], v[32:35]
    v_mfma_f32_16x16x32_bf16 v[36:39], v[108:111], v[60:63], v[36:39]
    v_mfma_f32_16x16x32_bf16 v[40:43], v[108:111], v[64:67], v[40:43]
    v_mfma_f32_16x16x32_bf16 v[44:47], v[112:115], v[60:63], v[44:47]
    v_mfma_f32_16x16x32_bf16 v[48:51], v[112:115], v[64:67], v[48:51]
    v_mfma_f32_16x16x32_bf16 v[52:55], v[116:119], v[60:63], v[52:55]
    v_mfma_f32_16x16x32_bf16 v[56:59], v[116:119], v[64:67], v[56:59]
    s_waitcnt vmcnt(7)
    s_barrier
    ds_read_b64_tr_b16 v[100:101], v8 offset:20480
    ds_read_b64_tr_b16 v[102:103], v8 offset:23040
    ds_read_b64_tr_b16 v[104:105], v8 offset:20512
    ds_read_b64_tr_b16 v[106:107], v8 offset:23072
    ds_read_b64_tr_b16 v[108:109], v8 offset:20544
    ds_read_b64_tr_b16 v[110:111], v8 offset:23104
    ds_read_b64_tr_b16 v[112:113], v8 offset:20576
    ds_read_b64_tr_b16 v[114:115], v8 offset:23136
    ds_read_b64_tr_b16 v[116:117], v8 offset:20608
    ds_read_b64_tr_b16 v[118:119], v8 offset:23168
    s_waitcnt lgkmcnt(0)
    v_mfma_f32_16x16x32_bf16 v[20:23], v[100:103], v[68:71], v[20:23]
    v_mfma_f32_16x16x32_bf16 v[24:27], v[100:103], v[72:75], v[24:27]
    v_mfma_f32_16x16x32_bf16 v[28:31], v[104:107], v[68:71], v[28:31]
    v_mfma_f32_16x16x32_bf16 v[32:35], v[104:107], v[72:75], v[32:35]
    v_mfma_f32_16x16x32_bf16 v[36:39], v[108:111], v[68:71], v[36:39]
    v_mfma_f32_16x16x32_bf16 v[40:43], v[108:111], v[72:75], v[40:43]
    v_mfma_f32_16x16x32_bf16 v[44:47], v[112:115], v[68:71], v[44:47]
    v_mfma_f32_16x16x32_bf16 v[48:51], v[112:115], v[72:75], v[48:51]
    v_mfma_f32_16x16x32_bf16 v[52:55], v[116:119], v[68:71], v[52:55]
    v_mfma_f32_16x16x32_bf16 v[56:59], v[116:119], v[72:75], v[56:59]
    s_waitcnt vmcnt(0)
    s_barrier
    ds_read_b64_tr_b16 v[100:101], v8 offset:40960
    ds_read_b64_tr_b16 v[102:103], v8 offset:43520
    ds_read_b64_tr_b16 v[104:105], v8 offset:40992
    ds_read_b64_tr_b16 v[106:107], v8 offset:43552
    ds_read_b64_tr_b16 v[108:109], v8 offset:41024
    ds_read_b64_tr_b16 v[110:111], v8 offset:43584
    ds_read_b64_tr_b16 v[112:113], v8 offset:41056
    ds_read_b64_tr_b16 v[114:115], v8 offset:43616
    ds_read_b64_tr_b16 v[116:117], v8 offset:41088
    ds_read_b64_tr_b16 v[118:119], v8 offset:43648
    s_waitcnt lgkmcnt(0)
    v_mfma_f32_16x16x32_bf16 v[20:23], v[100:103], v[76:79], v[20:23]
    v_mfma_f32_16x16x32_bf16 v[24:27], v[100:103], v[80:83], v[24:27]
    v_mfma_f32_16x16x32_bf16 v[28:31], v[104:107], v[76:79], v[28:31]
    v_mfma_f32_16x16x32_bf16 v[32:35], v[104:107], v[80:83], v[32:35]
    v_mfma_f32_16x16x32_bf16 v[36:39], v[108:111], v[76:79], v[36:39]
    v_mfma_f32_16x16x32_bf16 v[40:43], v[108:111], v[80:83], v[40:43]
    v_mfma_f32_16x16x32_bf16 v[44:47], v[112:115], v[76:79], v[44:47]
    v_mfma_f32_16x16x32_bf16 v[48:51], v[112:115], v[80:83], v[48:51]
    v_mfma_f32_16x16x32_bf16 v[52:55], v[116:119], v[76:79], v[52:55]
    v_mfma_f32_16x16x32_bf16 v[56:59], v[116:119], v[80:83], v[56:59]
    s_branch L_mb_red
L_mb_hi:
    s_mov_b32 s42, 0
    s_mov_b32 s43, 0
    s_mov_b32 s41, 0
    s_add_u32 s35, s42, 65536
    buffer_load_dwordx2 v[60:61], v7, s[8:11], s42 offen
    buffer_load_dwordx2 v[62:63], v7, s[8:11], s35 offen
    buffer_load_dwordx2 v[64:65], v7, s[8:11], s42 offen offset:128
    buffer_load_dwordx2 v[66:67], v7, s[8:11], s35 offen offset:128
    s_add_u32 s42, s42, 524288
    s_add_u32 m0, s28, 0
    s_nop 0
    buffer_load_dwordx4 v4, s[12:15], s43 offen lds
    s_add_u32 m0, s29, 0
    s_nop 0
    buffer_load_dwordx4 v5, s[12:15], s43 offen lds
    s_add_u32 s43, s43, 163840
    s_add_u32 s35, s42, 65536
    buffer_load_dwordx2 v[68:69], v7, s[8:11], s42 offen
    buffer_load_dwordx2 v[70:71], v7, s[8:11], s35 offen
    buffer_load_dwordx2 v[72:73], v7, s[8:11], s42 offen offset:128
    buffer_load_dwordx2 v[74:75], v7, s[8:11], s35 offen offset:128
    s_add_u32 s42, s42, 524288
    s_add_u32 m0, s28, 20480
    s_nop 0
    buffer_load_dwordx4 v4, s[12:15], s43 offen lds
    s_add_u32 m0, s29, 20480
    s_nop 0
    buffer_load_dwordx4 v5, s[12:15], s43 offen lds
    s_add_u32 s43, s43, 163840
    s_add_u32 s35, s42, 65536
    buffer_load_dwordx2 v[76:77], v7, s[8:11], s42 offen
    buffer_load_dwordx2 v[78:79], v7, s[8:11], s35 offen
    buffer_load_dwordx2 v[80:81], v7, s[8:11], s42 offen offset:128
    buffer_load_dwordx2 v[82:83], v7, s[8:11], s35 offen offset:128
    s_add_u32 s42, s42, 524288
    s_add_u32 m0, s28, 40960
    s_nop 0
    buffer_load_dwordx4 v4, s[12:15], s43 offen lds
    s_add_u32 m0, s29, 40960
    s_nop 0
    buffer_load_dwordx4 v5, s[12:15], s43 offen lds
    s_add_u32 s43, s43, 163840
    v_mov_b32 v20, 0
    v_mov_b32 v21, 0
    v_mov_b32 v22, 0
    v_mov_b32 v23, 0
    v_mov_b32 v24, 0
    v_mov_b32 v25, 0
    v_mov_b32 v26, 0
    v_mov_b32 v27, 0
    v_mov_b32 v28, 0
    v_mov_b32 v29, 0
    v_mov_b32 v30, 0
    v_mov_b32 v31, 0
    v_mov_b32 v32, 0
    v_mov_b32 v33, 0
    v_mov_b32 v34, 0
    v_mov_b32 v35, 0
    v_mov_b32 v36, 0
    v_mov_b32 v37, 0
    v_mov_b32 v38, 0
    v_mov_b32 v39, 0
    v_mov_b32 v40, 0
    v_mov_b32 v41, 0
    v_mov_b32 v42, 0
    v_mov_b32 v43, 0
    v_mov_b32 v44, 0
    v_mov_b32 v45, 0
    v_mov_b32 v46, 0
    v_mov_b32 v47, 0
    v_mov_b32 v48, 0
    v_mov_b32 v49, 0
    v_mov_b32 v50, 0
    v_mov_b32 v51, 0
    v_mov_b32 v52, 0
    v_mov_b32 v53, 0
    v_mov_b32 v54, 0
    v_mov_b32 v55, 0
    v_mov_b32 v56, 0
    v_mov_b32 v57, 0
    v_mov_b32 v58, 0
    v_mov_b32 v59, 0
    s_waitcnt vmcnt(12)
    s_barrier
    ds_read_b64_tr_b16 v[100:101], v8 offset:0
    ds_read_b64_tr_b16 v[102:103], v8 offset:2560
    ds_read_b64_tr_b16 v[104:105], v8 offset:32
    ds_read_b64_tr_b16 v[106:107], v8 offset:2592
    ds_read_b64_tr_b16 v[108:109], v8 offset:64
    ds_read_b64_tr_b16 v[110:111], v8 offset:2624
    ds_read_b64_tr_b16 v[112:113], v8 offset:96
    ds_read_b64_tr_b16 v[114:115], v8 offset:2656
    ds_read_b64_tr_b16 v[116:117], v8 offset:128
    ds_read_b64_tr_b16 v[118:119], v8 offset:2688
L_mb_lphi:
    s_waitcnt lgkmcnt(0)
    v_mfma_f32_16x16x32_bf16 v[20:23], v[100:103], v[60:63], v[20:23]
    v_mfma_f32_16x16x32_bf16 v[24:27], v[100:103], v[64:67], v[24:27]
    v_mfma_f32_16x16x32_bf16 v[28:31], v[104:107], v[60:63], v[28:31]
    v_mfma_f32_16x16x32_bf16 v[32:35], v[104:107], v[64:67], v[32:35]
    v_mfma_f32_16x16x32_bf16 v[36:39], v[108:111], v[60:63], v[36:39]
    v_mfma_f32_16x16x32_bf16 v[40:43], v[108:111], v[64:67], v[40:43]
    v_mfma_f32_16x16x32_bf16 v[44:47], v[112:115], v[60:63], v[44:47]
    v_mfma_f32_16x16x32_bf16 v[48:51], v[112:115], v[64:67], v[48:51]
    v_mfma_f32_16x16x32_bf16 v[52:55], v[116:119], v[60:63], v[52:55]
    v_mfma_f32_16x16x32_bf16 v[56:59], v[116:119], v[64:67], v[56:59]
    s_waitcnt vmcnt(6)
    s_barrier
    s_add_u32 s35, s42, 65536
    buffer_load_dwordx2 v[60:61], v7, s[8:11], s42 offen
    buffer_load_dwordx2 v[62:63], v7, s[8:11], s35 offen
    buffer_load_dwordx2 v[64:65], v7, s[8:11], s42 offen offset:128
    buffer_load_dwordx2 v[66:67], v7, s[8:11], s35 offen offset:128
    s_add_u32 s42, s42, 524288
    s_add_u32 m0, s28, 0
    s_nop 0
    buffer_load_dwordx4 v4, s[12:15], s43 offen lds
    s_add_u32 m0, s29, 0
    s_nop 0
    buffer_load_dwordx4 v5, s[12:15], s43 offen lds
    s_add_u32 s43, s43, 163840
    ds_read_b64_tr_b16 v[100:101], v8 offset:20480
    ds_read_b64_tr_b16 v[102:103], v8 offset:23040
    ds_read_b64_tr_b16 v[104:105], v8 offset:20512
    ds_read_b64_tr_b16 v[106:107], v8 offset:23072
    ds_read_b64_tr_b16 v[108:109], v8 offset:20544
    ds_read_b64_tr_b16 v[110:111], v8 offset:23104
    ds_read_b64_tr_b16 v[112:113], v8 offset:20576
    ds_read_b64_tr_b16 v[114:115], v8 offset:23136
    ds_read_b64_tr_b16 v[116:117], v8 offset:20608
    ds_read_b64_tr_b16 v[118:119], v8 offset:23168
    s_waitcnt lgkmcnt(0)
    v_mfma_f32_16x16x32_bf16 v[20:23], v[100:103], v[68:71], v[20:23]
    v_mfma_f32_16x16x32_bf16 v[24:27], v[100:103], v[72:75], v[24:27]
    v_mfma_f32_16x16x32_bf16 v[28:31], v[104:107], v[68:71], v[28:31]
    v_mfma_f32_16x16x32_bf16 v[32:35], v[104:107], v[72:75], v[32:35]
    v_mfma_f32_16x16x32_bf16 v[36:39], v[108:111], v[68:71], v[36:39]
    v_mfma_f32_16x16x32_bf16 v[40:43], v[108:111], v[72:75], v[40:43]
    v_mfma_f32_16x16x32_bf16 v[44:47], v[112:115], v[68:71], v[44:47]
    v_mfma_f32_16x16x32_bf16 v[48:51], v[112:115], v[72:75], v[48:51]
    v_mfma_f32_16x16x32_bf16 v[52:55], v[116:119], v[68:71], v[52:55]
    v_mfma_f32_16x16x32_bf16 v[56:59], v[116:119], v[72:75], v[56:59]
    s_waitcnt vmcnt(6)
    s_barrier
    s_add_u32 s35, s42, 65536
    buffer_load_dwordx2 v[68:69], v7, s[8:11], s42 offen
    buffer_load_dwordx2 v[70:71], v7, s[8:11], s35 offen
    buffer_load_dwordx2 v[72:73], v7, s[8:11], s42 offen offset:128
    buffer_load_dwordx2 v[74:75], v7, s[8:11], s35 offen offset:128
    s_add_u32 s42, s42, 524288
    s_add_u32 m0, s28, 20480
    s_nop 0
    buffer_load_dwordx4 v4, s[12:15], s43 offen lds
    s_add_u32 m0, s29, 20480
    s_nop 0
    buffer_load_dwordx4 v5, s[12:15], s43 offen lds
    s_add_u32 s43, s43, 163840
    ds_read_b64_tr_b16 v[100:101], v8 offset:40960
    ds_read_b64_tr_b16 v[102:103], v8 offset:43520
    ds_read_b64_tr_b16 v[104:105], v8 offset:40992
    ds_read_b64_tr_b16 v[106:107], v8 offset:43552
    ds_read_b64_tr_b16 v[108:109], v8 offset:41024
    ds_read_b64_tr_b16 v[110:111], v8 offset:43584
    ds_read_b64_tr_b16 v[112:113], v8 offset:41056
    ds_read_b64_tr_b16 v[114:115], v8 offset:43616
    ds_read_b64_tr_b16 v[116:117], v8 offset:41088
    ds_read_b64_tr_b16 v[118:119], v8 offset:43648
    s_waitcnt lgkmcnt(0)
    v_mfma_f32_16x16x32_bf16 v[20:23], v[100:103], v[76:79], v[20:23]
    v_mfma_f32_16x16x32_bf16 v[24:27], v[100:103], v[80:83], v[24:27]
    v_mfma_f32_16x16x32_bf16 v[28:31], v[104:107], v[76:79], v[28:31]
    v_mfma_f32_16x16x32_bf16 v[32:35], v[104:107], v[80:83], v[32:35]
    v_mfma_f32_16x16x32_bf16 v[36:39], v[108:111], v[76:79], v[36:39]
    v_mfma_f32_16x16x32_bf16 v[40:43], v[108:111], v[80:83], v[40:43]
    v_mfma_f32_16x16x32_bf16 v[44:47], v[112:115], v[76:79], v[44:47]
    v_mfma_f32_16x16x32_bf16 v[48:51], v[112:115], v[80:83], v[48:51]
    v_mfma_f32_16x16x32_bf16 v[52:55], v[116:119], v[76:79], v[52:55]
    v_mfma_f32_16x16x32_bf16 v[56:59], v[116:119], v[80:83], v[56:59]
    s_waitcnt vmcnt(6)
    s_barrier
    s_add_u32 s35, s42, 65536
    buffer_load_dwordx2 v[76:77], v7, s[8:11], s42 offen
    buffer_load_dwordx2 v[78:79], v7, s[8:11], s35 offen
    buffer_load_dwordx2 v[80:81], v7, s[8:11], s42 offen offset:128
    buffer_load_dwordx2 v[82:83], v7, s[8:11], s35 offen offset:128
    s_add_u32 s42, s42, 524288
    s_add_u32 m0, s28, 40960
    s_nop 0
    buffer_load_dwordx4 v4, s[12:15], s43 offen lds
    s_add_u32 m0, s29, 40960
    s_nop 0
    buffer_load_dwordx4 v5, s[12:15], s43 offen lds
    s_add_u32 s43, s43, 163840
    ds_read_b64_tr_b16 v[100:101], v8 offset:0
    ds_read_b64_tr_b16 v[102:103], v8 offset:2560
    ds_read_b64_tr_b16 v[104:105], v8 offset:32
    ds_read_b64_tr_b16 v[106:107], v8 offset:2592
    ds_read_b64_tr_b16 v[108:109], v8 offset:64
    ds_read_b64_tr_b16 v[110:111], v8 offset:2624
    ds_read_b64_tr_b16 v[112:113], v8 offset:96
    ds_read_b64_tr_b16 v[114:115], v8 offset:2656
    ds_read_b64_tr_b16 v[116:117], v8 offset:128
    ds_read_b64_tr_b16 v[118:119], v8 offset:2688
    s_add_u32 s41, s41, 1
    s_cmp_lt_u32 s41, 3
    s_cbranch_scc1 L_mb_lphi
    s_waitcnt lgkmcnt(0)
    v_mfma_f32_16x16x32_bf16 v[20:23], v[100:103], v[60:63], v[20:23]
    v_mfma_f32_16x16x32_bf16 v[24:27], v[100:103], v[64:67], v[24:27]
    v_mfma_f32_16x16x32_bf16 v[28:31], v[104:107], v[60:63], v[28:31]
    v_mfma_f32_16x16x32_bf16 v[32:35], v[104:107], v[64:67], v[32:35]
    v_mfma_f32_16x16x32_bf16 v[36:39], v[108:111], v[60:63], v[36:39]
    v_mfma_f32_16x16x32_bf16 v[40:43], v[108:111], v[64:67], v[40:43]
    v_mfma_f32_16x16x32_bf16 v[44:47], v[112:115], v[60:63], v[44:47]
    v_mfma_f32_16x16x32_bf16 v[48:51], v[112:115], v[64:67], v[48:51]
    v_mfma_f32_16x16x32_bf16 v[52:55], v[116:119], v[60:63], v[52:55]
    v_mfma_f32_16x16x32_bf16 v[56:59], v[116:119], v[64:67], v[56:59]
    s_waitcnt vmcnt(6)
    s_barrier
    ds_read_b64_tr_b16 v[100:101], v8 offset:20480
    ds_read_b64_tr_b16 v[102:103], v8 offset:23040
    ds_read_b64_tr_b16 v[104:105], v8 offset:20512
    ds_read_b64_tr_b16 v[106:107], v8 offset:23072
    ds_read_b64_tr_b16 v[108:109], v8 offset:20544
    ds_read_b64_tr_b16 v[110:111], v8 offset:23104
    ds_read_b64_tr_b16 v[112:113], v8 offset:20576
    ds_read_b64_tr_b16 v[114:115], v8 offset:23136
    ds_read_b64_tr_b16 v[116:117], v8 offset:20608
    ds_read_b64_tr_b16 v[118:119], v8 offset:23168
    s_waitcnt lgkmcnt(0)
    v_mfma_f32_16x16x32_bf16 v[20:23], v[100:103], v[68:71], v[20:23]
    v_mfma_f32_16x16x32_bf16 v[24:27], v[100:103], v[72:75], v[24:27]
    v_mfma_f32_16x16x32_bf16 v[28:31], v[104:107], v[68:71], v[28:31]
    v_mfma_f32_16x16x32_bf16 v[32:35], v[104:107], v[72:75], v[32:35]
    v_mfma_f32_16x16x32_bf16 v[36:39], v[108:111], v[68:71], v[36:39]
    v_mfma_f32_16x16x32_bf16 v[40:43], v[108:111], v[72:75], v[40:43]
    v_mfma_f32_16x16x32_bf16 v[44:47], v[112:115], v[68:71], v[44:47]
    v_mfma_f32_16x16x32_bf16 v[48:51], v[112:115], v[72:75], v[48:51]
    v_mfma_f32_16x16x32_bf16 v[52:55], v[116:119], v[68:71], v[52:55]
    v_mfma_f32_16x16x32_bf16 v[56:59], v[116:119], v[72:75], v[56:59]
    s_waitcnt vmcnt(0)
    s_barrier
    ds_read_b64_tr_b16 v[100:101], v8 offset:40960
    ds_read_b64_tr_b16 v[102:103], v8 offset:43520
    ds_read_b64_tr_b16 v[104:105], v8 offset:40992
    ds_read_b64_tr_b16 v[106:107], v8 offset:43552
    ds_read_b64_tr_b16 v[108:109], v8 offset:41024
    ds_read_b64_tr_b16 v[110:111], v8 offset:43584
    ds_read_b64_tr_b16 v[112:113], v8 offset:41056
    ds_read_b64_tr_b16 v[114:115], v8 offset:43616
    ds_read_b64_tr_b16 v[116:117], v8 offset:41088
    ds_read_b64_tr_b16 v[118:119], v8 offset:43648
    s_waitcnt lgkmcnt(0)
    v_mfma_f32_16x16x32_bf16 v[20:23], v[100:103], v[76:79], v[20:23]
    v_mfma_f32_16x16x32_bf16 v[24:27], v[100:103], v[80:83], v[24:27]
    v_mfma_f32_16x16x32_bf16 v[28:31], v[104:107], v[76:79], v[28:31]
    v_mfma_f32_16x16x32_bf16 v[32:35], v[104:107], v[80:83], v[32:35]
    v_mfma_f32_16x16x32_bf16 v[36:39], v[108:111], v[76:79], v[36:39]
    v_mfma_f32_16x16x32_bf16 v[40:43], v[108:111], v[80:83], v[40:43]
    v_mfma_f32_16x16x32_bf16 v[44:47], v[112:115], v[76:79], v[44:47]
    v_mfma_f32_16x16x32_bf16 v[48:51], v[112:115], v[80:83], v[48:51]
    v_mfma_f32_16x16x32_bf16 v[52:55], v[116:119], v[76:79], v[52:55]
    v_mfma_f32_16x16x32_bf16 v[56:59], v[116:119], v[80:83], v[56:59]
L_mb_red:
    s_barrier
    s_nop 4
    ds_write_b128 v9, v[20:23] offset:0
    ds_write_b128 v9, v[24:27] offset:5120
    ds_write_b128 v9, v[28:31] offset:64
    ds_write_b128 v9, v[32:35] offset:5184
    ds_write_b128 v9, v[36:39] offset:128
    ds_write_b128 v9, v[40:43] offset:5248
    ds_write_b128 v9, v[44:47] offset:192
    ds_write_b128 v9, v[48:51] offset:5312
    ds_write_b128 v9, v[52:55] offset:256
    ds_write_b128 v9, v[56:59] offset:5376
    s_waitcnt lgkmcnt(0)
    s_barrier
    v_add_u32 v10, 0, v0
    v_min_u32 v10, 639, v10
    v_mul_u32_u24 v11, 6554, v10
    v_lshrrev_b32 v11, 16, v11
    v_mul_u32_u24 v12, 10, v11
    v_sub_u32 v12, v10, v12
    v_bfe_u32 v16, v11, 1, 2
    v_lshlrev_b32 v17, 1, v12
    v_xor_b32 v17, v17, v16
    v_mul_u32_u24 v18, 320, v11
    v_lshl_add_u32 v13, v17, 4, v18
    v_xor_b32 v17, 1, v17
    v_lshl_add_u32 v15, v17, 4, v18
    s_lshl_b32 s37, s20, 6
    v_add_u32 v14, s37, v11
    v_mul_u32_u24 v14, 1280, v14
    v_lshl_add_u32 v14, v12, 4, v14
    s_mul_i32 s37, s21, 160
    v_add_u32 v14, s37, v14
    v_lshl_add_u32 v16, v12, 4, s37
    buffer_load_dwordx4 v[60:63], v16, s[44:47], 0 offen
    ds_read_b128 v[20:23], v13 offset:0
    ds_read_b128 v[24:27], v15 offset:0
    ds_read_b128 v[28:31], v13 offset:20480
    ds_read_b128 v[32:35], v15 offset:20480
    ds_read_b128 v[36:39], v13 offset:40960
    ds_read_b128 v[40:43], v15 offset:40960
    ds_read_b128 v[44:47], v13 offset:61440
    ds_read_b128 v[48:51], v15 offset:61440
    s_waitcnt lgkmcnt(0)
    v_add_f32 v20, v20, v28
    v_add_f32 v21, v21, v29
    v_add_f32 v22, v22, v30
    v_add_f32 v23, v23, v31
    v_add_f32 v24, v24, v32
    v_add_f32 v25, v25, v33
    v_add_f32 v26, v26, v34
    v_add_f32 v27, v27, v35
    v_add_f32 v36, v36, v44
    v_add_f32 v37, v37, v45
    v_add_f32 v38, v38, v46
    v_add_f32 v39, v39, v47
    v_add_f32 v40, v40, v48
    v_add_f32 v41, v41, v49
    v_add_f32 v42, v42, v50
    v_add_f32 v43, v43, v51
    v_add_f32 v20, v20, v36
    v_add_f32 v21, v21, v37
    v_add_f32 v22, v22, v38
    v_add_f32 v23, v23, v39
    v_add_f32 v24, v24, v40
    v_add_f32 v25, v25, v41
    v_add_f32 v26, v26, v42
    v_add_f32 v27, v27, v43
    v_cvt_pk_bf16_f32 v20, v20, v21
    v_and_b32 v21, 0xffff0000, v20
    v_lshlrev_b32 v20, 16, v20
    v_cvt_pk_bf16_f32 v22, v22, v23
    v_and_b32 v23, 0xffff0000, v22
    v_lshlrev_b32 v22, 16, v22
    v_cvt_pk_bf16_f32 v24, v24, v25
    v_and_b32 v25, 0xffff0000, v24
    v_lshlrev_b32 v24, 16, v24
    v_cvt_pk_bf16_f32 v26, v26, v27
    v_and_b32 v27, 0xffff0000, v26
    v_lshlrev_b32 v26, 16, v26
    s_waitcnt vmcnt(0)
    v_lshlrev_b32 v68, 16, v60
    v_and_b32 v69, 0xffff0000, v60
    v_lshlrev_b32 v70, 16, v61
    v_and_b32 v71, 0xffff0000, v61
    v_lshlrev_b32 v72, 16, v62
    v_and_b32 v73, 0xffff0000, v62
    v_lshlrev_b32 v74, 16, v63
    v_and_b32 v75, 0xffff0000, v63
    v_add_f32 v20, v20, v68
    v_add_f32 v21, v21, v69
    v_add_f32 v22, v22, v70
    v_add_f32 v23, v23, v71
    v_add_f32 v24, v24, v72
    v_add_f32 v25, v25, v73
    v_add_f32 v26, v26, v74
    v_add_f32 v27, v27, v75
    v_cvt_pk_bf16_f32 v20, v20, v21
    v_and_b32 v21, 0xffff0000, v20
    v_lshlrev_b32 v20, 16, v20
    v_cvt_pk_bf16_f32 v22, v22, v23
    v_and_b32 v23, 0xffff0000, v22
    v_lshlrev_b32 v22, 16, v22
    v_cvt_pk_bf16_f32 v24, v24, v25
    v_and_b32 v25, 0xffff0000, v24
    v_lshlrev_b32 v24, 16, v24
    v_cvt_pk_bf16_f32 v26, v26, v27
    v_and_b32 v27, 0xffff0000, v26
    v_lshlrev_b32 v26, 16, v26
    v_mul_f32 v68, 0xbfb8aa3b, v20
    v_mul_f32 v69, 0xbfb8aa3b, v21
    v_mul_f32 v70, 0xbfb8aa3b, v22
    v_mul_f32 v71, 0xbfb8aa3b, v23
    v_mul_f32 v72, 0xbfb8aa3b, v24
    v_mul_f32 v73, 0xbfb8aa3b, v25
    v_mul_f32 v74, 0xbfb8aa3b, v26
    v_mul_f32 v75, 0xbfb8aa3b, v27
    v_exp_f32 v68, v68
    v_exp_f32 v69, v69
    v_exp_f32 v70, v70
    v_exp_f32 v71, v71
    v_exp_f32 v72, v72
    v_exp_f32 v73, v73
    v_exp_f32 v74, v74
    v_exp_f32 v75, v75
    s_nop 0
    v_add_f32 v68, 1.0, v68
    v_add_f32 v69, 1.0, v69
    v_add_f32 v70, 1.0, v70
    v_add_f32 v71, 1.0, v71
    v_add_f32 v72, 1.0, v72
    v_add_f32 v73, 1.0, v73
    v_add_f32 v74, 1.0, v74
    v_add_f32 v75, 1.0, v75
    v_rcp_f32 v68, v68
    v_rcp_f32 v69, v69
    v_rcp_f32 v70, v70
    v_rcp_f32 v71, v71
    v_rcp_f32 v72, v72
    v_rcp_f32 v73, v73
    v_rcp_f32 v74, v74
    v_rcp_f32 v75, v75
    s_nop 0
    v_mul_f32 v20, v20, v68
    v_mul_f32 v21, v21, v69
    v_mul_f32 v22, v22, v70
    v_mul_f32 v23, v23, v71
    v_mul_f32 v24, v24, v72
    v_mul_f32 v25, v25, v73
    v_mul_f32 v26, v26, v74
    v_mul_f32 v27, v27, v75
    v_cvt_pk_bf16_f32 v120, v20, v21
    v_cvt_pk_bf16_f32 v121, v22, v23
    v_cvt_pk_bf16_f32 v122, v24, v25
    v_cvt_pk_bf16_f32 v123, v26, v27
    v_add_u32 v10, 512, v0
    v_min_u32 v10, 639, v10
    v_mul_u32_u24 v11, 6554, v10
    v_lshrrev_b32 v11, 16, v11
    v_mul_u32_u24 v12, 10, v11
    v_sub_u32 v12, v10, v12
    v_bfe_u32 v16, v11, 1, 2
    v_lshlrev_b32 v17, 1, v12
    v_xor_b32 v17, v17, v16
    v_mul_u32_u24 v18, 320, v11
    v_lshl_add_u32 v13, v17, 4, v18
    v_xor_b32 v17, 1, v17
    v_lshl_add_u32 v15, v17, 4, v18
    s_lshl_b32 s37, s20, 6
    v_add_u32 v14, s37, v11
    v_mul_u32_u24 v14, 1280, v14
    v_lshl_add_u32 v14, v12, 4, v14
    s_mul_i32 s37, s21, 160
    v_add_u32 v14, s37, v14
    v_lshl_add_u32 v16, v12, 4, s37
    buffer_load_dwordx4 v[60:63], v16, s[44:47], 0 offen
    ds_read_b128 v[20:23], v13 offset:0
    ds_read_b128 v[24:27], v15 offset:0
    ds_read_b128 v[28:31], v13 offset:20480
    ds_read_b128 v[32:35], v15 offset:20480
    ds_read_b128 v[36:39], v13 offset:40960
    ds_read_b128 v[40:43], v15 offset:40960
    ds_read_b128 v[44:47], v13 offset:61440
    ds_read_b128 v[48:51], v15 offset:61440
    s_waitcnt lgkmcnt(0)
    v_add_f32 v20, v20, v28
    v_add_f32 v21, v21, v29
    v_add_f32 v22, v22, v30
    v_add_f32 v23, v23, v31
    v_add_f32 v24, v24, v32
    v_add_f32 v25, v25, v33
    v_add_f32 v26, v26, v34
    v_add_f32 v27, v27, v35
    v_add_f32 v36, v36, v44
    v_add_f32 v37, v37, v45
    v_add_f32 v38, v38, v46
    v_add_f32 v39, v39, v47
    v_add_f32 v40, v40, v48
    v_add_f32 v41, v41, v49
    v_add_f32 v42, v42, v50
    v_add_f32 v43, v43, v51
    v_add_f32 v20, v20, v36
    v_add_f32 v21, v21, v37
    v_add_f32 v22, v22, v38
    v_add_f32 v23, v23, v39
    v_add_f32 v24, v24, v40
    v_add_f32 v25, v25, v41
    v_add_f32 v26, v26, v42
    v_add_f32 v27, v27, v43
    v_cvt_pk_bf16_f32 v20, v20, v21
    v_and_b32 v21, 0xffff0000, v20
    v_lshlrev_b32 v20, 16, v20
    v_cvt_pk_bf16_f32 v22, v22, v23
    v_and_b32 v23, 0xffff0000, v22
    v_lshlrev_b32 v22, 16, v22
    v_cvt_pk_bf16_f32 v24, v24, v25
    v_and_b32 v25, 0xffff0000, v24
    v_lshlrev_b32 v24, 16, v24
    v_cvt_pk_bf16_f32 v26, v26, v27
    v_and_b32 v27, 0xffff0000, v26
    v_lshlrev_b32 v26, 16, v26
    s_waitcnt vmcnt(0)
    v_lshlrev_b32 v68, 16, v60
    v_and_b32 v69, 0xffff0000, v60
    v_lshlrev_b32 v70, 16, v61
    v_and_b32 v71, 0xffff0000, v61
    v_lshlrev_b32 v72, 16, v62
    v_and_b32 v73, 0xffff0000, v62
    v_lshlrev_b32 v74, 16, v63
    v_and_b32 v75, 0xffff0000, v63
    v_add_f32 v20, v20, v68
    v_add_f32 v21, v21, v69
    v_add_f32 v22, v22, v70
    v_add_f32 v23, v23, v71
    v_add_f32 v24, v24, v72
    v_add_f32 v25, v25, v73
    v_add_f32 v26, v26, v74
    v_add_f32 v27, v27, v75
    v_cvt_pk_bf16_f32 v20, v20, v21
    v_and_b32 v21, 0xffff0000, v20
    v_lshlrev_b32 v20, 16, v20
    v_cvt_pk_bf16_f32 v22, v22, v23
    v_and_b32 v23, 0xffff0000, v22
    v_lshlrev_b32 v22, 16, v22
    v_cvt_pk_bf16_f32 v24, v24, v25
    v_and_b32 v25, 0xffff0000, v24
    v_lshlrev_b32 v24, 16, v24
    v_cvt_pk_bf16_f32 v26, v26, v27
    v_and_b32 v27, 0xffff0000, v26
    v_lshlrev_b32 v26, 16, v26
    v_mul_f32 v68, 0xbfb8aa3b, v20
    v_mul_f32 v69, 0xbfb8aa3b, v21
    v_mul_f32 v70, 0xbfb8aa3b, v22
    v_mul_f32 v71, 0xbfb8aa3b, v23
    v_mul_f32 v72, 0xbfb8aa3b, v24
    v_mul_f32 v73, 0xbfb8aa3b, v25
    v_mul_f32 v74, 0xbfb8aa3b, v26
    v_mul_f32 v75, 0xbfb8aa3b, v27
    v_exp_f32 v68, v68
    v_exp_f32 v69, v69
    v_exp_f32 v70, v70
    v_exp_f32 v71, v71
    v_exp_f32 v72, v72
    v_exp_f32 v73, v73
    v_exp_f32 v74, v74
    v_exp_f32 v75, v75
    s_nop 0
    v_add_f32 v68, 1.0, v68
    v_add_f32 v69, 1.0, v69
    v_add_f32 v70, 1.0, v70
    v_add_f32 v71, 1.0, v71
    v_add_f32 v72, 1.0, v72
    v_add_f32 v73, 1.0, v73
    v_add_f32 v74, 1.0, v74
    v_add_f32 v75, 1.0, v75
    v_rcp_f32 v68, v68
    v_rcp_f32 v69, v69
    v_rcp_f32 v70, v70
    v_rcp_f32 v71, v71
    v_rcp_f32 v72, v72
    v_rcp_f32 v73, v73
    v_rcp_f32 v74, v74
    v_rcp_f32 v75, v75
    s_nop 0
    v_mul_f32 v20, v20, v68
    v_mul_f32 v21, v21, v69
    v_mul_f32 v22, v22, v70
    v_mul_f32 v23, v23, v71
    v_mul_f32 v24, v24, v72
    v_mul_f32 v25, v25, v73
    v_mul_f32 v26, v26, v74
    v_mul_f32 v27, v27, v75
    v_cvt_pk_bf16_f32 v124, v20, v21
    v_cvt_pk_bf16_f32 v125, v22, v23
    v_cvt_pk_bf16_f32 v126, v24, v25
    v_cvt_pk_bf16_f32 v127, v26, v27
L_mb_oproj:
    s_barrier
    s_cmp_eq_u32 s23, 0
    s_cbranch_scc1 L_mb_w0skip
    s_mov_b32 s34, 0
    s_add_u32 m0, s28, 0
    s_nop 0
    buffer_load_dwordx4 v4, s[52:55], s34 offen lds
    s_add_u32 m0, s29, 0
    s_nop 0
    buffer_load_dwordx4 v5, s[52:55], s34 offen lds
    s_add_u32 m0, s30, 0
    s_nop 0
    buffer_load_dwordx4 v6, s[52:55], s34 offen lds
    s_mov_b32 s34, 163840
    s_add_u32 m0, s28, 20480
    s_nop 0
    buffer_load_dwordx4 v4, s[52:55], s34 offen lds
    s_add_u32 m0, s29, 20480
    s_nop 0
    buffer_load_dwordx4 v5, s[52:55], s34 offen lds
    s_add_u32 m0, s30, 20480
    s_nop 0
    buffer_load_dwordx4 v6, s[52:55], s34 offen lds
    s_mov_b32 s34, 327680
    s_add_u32 m0, s28, 40960
    s_nop 0
    buffer_load_dwordx4 v4, s[52:55], s34 offen lds
    s_add_u32 m0, s29, 40960
    s_nop 0
    buffer_load_dwordx4 v5, s[52:55], s34 offen lds
    s_add_u32 m0, s30, 40960
    s_nop 0
    buffer_load_dwordx4 v6, s[52:55], s34 offen lds
L_mb_w0skip:
    s_cmp_lg_u32 s23, 0
    s_cbranch_scc1 L_mba_wd
    s_mov_b32 s97, 0
    s_lshr_b32 s37, s20, 2
    s_lshl_b32 s37, s37, 12
    s_add_u32 s37, s37, 21495808
    v_and_b32 v10, 31, v2
    v_lshl_add_u32 v10, v10, 7, s37
    s_mov_b32 s38, 0
L_mba_poll:
    global_load_dwordx2 v[12:13], v10, s[4:5] sc1
    s_waitcnt vmcnt(0)
    v_subrev_u32 v11, s90, v12
    v_add_u32 v11, -1, v11
    v_xor_b32 v13, v13, v12
    v_xor_b32 v13, 0x5bd1e995, v13
    v_lshrrev_b32 v11, 24, v11
    v_or_b32 v11, v11, v13
    v_cmp_ne_u32 vcc, 0, v11
    s_nop 3
    s_cmp_eq_u64 vcc, 0
    s_cbranch_scc1 L_mba_pok
    s_sleep 5
    s_add_u32 s38, s38, 1
    s_cmp_lt_u32 s38, 400
    s_cbranch_scc1 L_mba_poll
    s_ff1_i32_b64 s39, vcc
    s_add_u32 s97, s39, 1
L_mba_pok:
    v_mov_b32 v10, 61440
    v_mov_b32 v11, s97
    ds_write_b32 v10, v11
L_mba_wd:
    s_waitcnt lgkmcnt(0)
    s_barrier
    v_mov_b32 v10, 61440
    ds_read_b32 v11, v10
    s_waitcnt lgkmcnt(0)
    v_readfirstlane_b32 s97, v11
    s_nop 3
    s_cmp_eq_u32 s97, 0
    s_cbranch_scc1 L_mb_go
    s_waitcnt vmcnt(0)
    s_barrier
    s_sub_u32 s39, s97, 1
    s_lshr_b32 s40, s39, 2
    s_and_b32 s41, s39, 3
    s_lshl_b32 s41, s41, 3
    s_or_b32 s40, s40, s41
    s_lshr_b32 s41, s20, 2
    s_lshl_b32 s41, s41, 5
    s_or_b32 s2, s40, s41
    s_setprio 0
    s_branch L_k2_att
L_mb_resume:
    s_setprio 0
    s_and_b32 s20, s3, 7
    s_lshl_b32 s20, s20, 2
    s_bfe_u32 s21, s3, 0x20003
    s_add_u32 s20, s20, s21
    s_lshr_b32 s21, s3, 5
    v_lshrrev_b32 v10, 6, v0
    v_and_b32 v2, 63, v0
    s_nop 0
    v_readfirstlane_b32 s23, v10
    v_and_b32 v3, 15, v2
    v_lshrrev_b32 v1, 4, v2
    s_and_b32 s24, s23, 1
    s_lshr_b32 s25, s23, 1
    s_add_u32 s37, s23, 0
    s_min_u32 s37, s37, 19
    s_lshl_b32 s28, s37, 10
    v_lshl_add_u32 v10, v2, 4, s28
    v_lshrrev_b32 v11, 5, v10
    v_mul_u32_u24 v11, 13108, v11
    v_lshrrev_b32 v11, 16, v11
    v_mul_u32_u24 v12, 160, v11
    v_sub_u32 v12, v10, v12
    v_mul_u32_u24 v11, 1280, v11
    s_mul_i32 s37, s21, 160
    v_add3_u32 v4, v11, v12, s37
    s_add_u32 s37, s23, 8
    s_min_u32 s37, s37, 19
    s_lshl_b32 s29, s37, 10
    v_lshl_add_u32 v10, v2, 4, s29
    v_lshrrev_b32 v11, 5, v10
    v_mul_u32_u24 v11, 13108, v11
    v_lshrrev_b32 v11, 16, v11
    v_mul_u32_u24 v12, 160, v11
    v_sub_u32 v12, v10, v12
    v_mul_u32_u24 v11, 1280, v11
    s_mul_i32 s37, s21, 160
    v_add3_u32 v5, v11, v12, s37
    s_add_u32 s37, s23, 16
    s_min_u32 s37, s37, 19
    s_lshl_b32 s30, s37, 10
    v_lshl_add_u32 v10, v2, 4, s30
    v_lshrrev_b32 v11, 5, v10
    v_mul_u32_u24 v11, 13108, v11
    v_lshrrev_b32 v11, 16, v11
    v_mul_u32_u24 v12, 160, v11
    v_sub_u32 v12, v10, v12
    v_mul_u32_u24 v11, 1280, v11
    s_mul_i32 s37, s21, 160
    v_add3_u32 v6, v11, v12, s37
    s_lshl_b32 s37, s25, 3
    v_add_u32 v10, s37, v1
    v_lshlrev_b32 v10, 14, v10
    s_lshl_b32 s37, s20, 6
    s_lshl_b32 s38, s24, 5
    s_add_u32 s37, s37, s38
    v_add_u32 v11, s37, v3
    v_lshl_add_u32 v7, v11, 3, v10
    v_bfe_u32 v10, v2, 2, 2
    v_lshl_add_u32 v10, v1, 2, v10
    s_lshl_b32 s37, s25, 5
    v_add_u32 v10, s37, v10
    v_mul_u32_u24 v10, 160, v10
    v_and_b32 v11, 3, v2
    v_lshl_add_u32 v8, v11, 3, v10
    s_mul_i32 s37, s25, 20480
    s_mul_i32 s38, s24, 10240
    s_add_u32 s37, s37, s38
    v_bfe_u32 v10, v3, 1, 2
    v_xor_b32 v10, v10, v1
    v_mul_u32_u24 v11, 320, v3
    v_lshl_add_u32 v10, v10, 4, v11
    v_add_u32 v9, s37, v10
    s_load_dwordx4 s[56:59], s[0:1], 48
    s_load_dwordx2 s[60:61], s[0:1], 16
    s_load_dwordx2 s[62:63], s[0:1], 0
    s_load_dwordx4 s[64:67], s[0:1], 64
    s_waitcnt lgkmcnt(0)
    s_add_u32 s8, s4, 9437184
    s_addc_u32 s9, s5, 0
    s_mov_b32 s10, 6291456
    s_mov_b32 s11, 0x00020000
    s_add_u32 s12, s56, 0
    s_addc_u32 s13, s57, 0
    s_mov_b32 s14, 1966080
    s_mov_b32 s15, 0x00020000
    s_add_u32 s16, s64, 0
    s_addc_u32 s17, s65, 0
    s_mov_b32 s18, 2621440
    s_mov_b32 s19, 0x00020000
    s_add_u32 s44, s58, 0
    s_addc_u32 s45, s59, 0
    s_mov_b32 s46, 1280
    s_mov_b32 s47, 0x00020000
    s_add_u32 s48, s62, 0
    s_addc_u32 s49, s63, 0
    s_mov_b32 s50, 2621440
    s_mov_b32 s51, 0x00020000
    s_add_u32 s52, s60, 0
    s_addc_u32 s53, s61, 0
    s_mov_b32 s54, 819200
    s_mov_b32 s55, 0x00020000
    s_add_u32 s68, s4, 15728640
    s_addc_u32 s69, s5, 0
    s_mov_b32 s70, 2621440
    s_mov_b32 s71, 0x00020000
    s_branch L_mb_oproj
L_mb_go:
    s_cmp_lg_u32 s23, 0
    s_cbranch_scc1 L_mb_w0done
    s_mov_b32 s34, 0
    s_add_u32 m0, s28, 0
    s_nop 0
    buffer_load_dwordx4 v4, s[52:55], s34 offen lds
    s_add_u32 m0, s29, 0
    s_nop 0
    buffer_load_dwordx4 v5, s[52:55], s34 offen lds
    s_add_u32 m0, s30, 0
    s_nop 0
    buffer_load_dwordx4 v6, s[52:55], s34 offen lds
    s_mov_b32 s34, 163840
    s_add_u32 m0, s28, 20480
    s_nop 0
    buffer_load_dwordx4 v4, s[52:55], s34 offen lds
    s_add_u32 m0, s29, 20480
    s_nop 0
    buffer_load_dwordx4 v5, s[52:55], s34 offen lds
    s_add_u32 m0, s30, 20480
    s_nop 0
    buffer_load_dwordx4 v6, s[52:55], s34 offen lds
    s_mov_b32 s34, 327680
    s_add_u32 m0, s28, 40960
    s_nop 0
    buffer_load_dwordx4 v4, s[52:55], s34 offen lds
    s_add_u32 m0, s29, 40960
    s_nop 0
    buffer_load_dwordx4 v5, s[52:55], s34 offen lds
    s_add_u32 m0, s30, 40960
    s_nop 0
    buffer_load_dwordx4 v6, s[52:55], s34 offen lds
L_mb_w0done:
    s_barrier
    s_mov_b32 s34, 0
    s_add_u32 s35, s34, 65536
    buffer_load_dwordx2 v[60:61], v7, s[68:71], s34 offen
    buffer_load_dwordx2 v[62:63], v7, s[68:71], s35 offen
    buffer_load_dwordx2 v[64:65], v7, s[68:71], s34 offen offset:128
    buffer_load_dwordx2 v[66:67], v7, s[68:71], s35 offen offset:128
    s_mov_b32 s34, 491520
    s_add_u32 m0, s28, 61440
    s_nop 0
    buffer_load_dwordx4 v4, s[52:55], s34 offen lds
    s_add_u32 m0, s29, 61440
    s_nop 0
    buffer_load_dwordx4 v5, s[52:55], s34 offen lds
    s_add_u32 m0, s30, 61440
    s_nop 0
    buffer_load_dwordx4 v6, s[52:55], s34 offen lds
    s_mov_b32 s34, 524288
    s_add_u32 s35, s34, 65536
    buffer_load_dwordx2 v[68:69], v7, s[68:71], s34 offen
    buffer_load_dwordx2 v[70:71], v7, s[68:71], s35 offen
    buffer_load_dwordx2 v[72:73], v7, s[68:71], s34 offen offset:128
    buffer_load_dwordx2 v[74:75], v7, s[68:71], s35 offen offset:128
    s_mov_b32 s34, 1048576
    s_add_u32 s35, s34, 65536
    buffer_load_dwordx2 v[76:77], v7, s[68:71], s34 offen
    buffer_load_dwordx2 v[78:79], v7, s[68:71], s35 offen
    buffer_load_dwordx2 v[80:81], v7, s[68:71], s34 offen offset:128
    buffer_load_dwordx2 v[82:83], v7, s[68:71], s35 offen offset:128
    s_mov_b32 s34, 1572864
    s_add_u32 s35, s34, 65536
    buffer_load_dwordx2 v[84:85], v7, s[68:71], s34 offen
    buffer_load_dwordx2 v[86:87], v7, s[68:71], s35 offen
    buffer_load_dwordx2 v[88:89], v7, s[68:71], s34 offen offset:128
    buffer_load_dwordx2 v[90:91], v7, s[68:71], s35 offen offset:128
    s_mov_b32 s34, 2097152
    s_add_u32 s35, s34, 65536
    buffer_load_dwordx2 v[92:93], v7, s[68:71], s34 offen
    buffer_load_dwordx2 v[94:95], v7, s[68:71], s35 offen
    buffer_load_dwordx2 v[96:97], v7, s[68:71], s34 offen offset:128
    buffer_load_dwordx2 v[98:99], v7, s[68:71], s35 offen offset:128
    s_waitcnt vmcnt(19)
    s_barrier
    ds_read_b64_tr_b16 v[100:101], v8 offset:0
    ds_read_b64_tr_b16 v[102:103], v8 offset:2560
    ds_read_b64_tr_b16 v[104:105], v8 offset:32
    ds_read_b64_tr_b16 v[106:107], v8 offset:2592
    ds_read_b64_tr_b16 v[108:109], v8 offset:64
    ds_read_b64_tr_b16 v[110:111], v8 offset:2624
    ds_read_b64_tr_b16 v[112:113], v8 offset:96
    ds_read_b64_tr_b16 v[114:115], v8 offset:2656
    ds_read_b64_tr_b16 v[116:117], v8 offset:128
    ds_read_b64_tr_b16 v[118:119], v8 offset:2688
    s_waitcnt lgkmcnt(0)
    v_mfma_f32_16x16x32_bf16 v[20:23], v[100:103], v[60:63], 0
    v_mfma_f32_16x16x32_bf16 v[24:27], v[100:103], v[64:67], 0
    v_mfma_f32_16x16x32_bf16 v[28:31], v[104:107], v[60:63], 0
    v_mfma_f32_16x16x32_bf16 v[32:35], v[104:107], v[64:67], 0
    v_mfma_f32_16x16x32_bf16 v[36:39], v[108:111], v[60:63], 0
    v_mfma_f32_16x16x32_bf16 v[40:43], v[108:111], v[64:67], 0
    v_mfma_f32_16x16x32_bf16 v[44:47], v[112:115], v[60:63], 0
    v_mfma_f32_16x16x32_bf16 v[48:51], v[112:115], v[64:67], 0
    v_mfma_f32_16x16x32_bf16 v[52:55], v[116:119], v[60:63], 0
    v_mfma_f32_16x16x32_bf16 v[56:59], v[116:119], v[64:67], 0
    s_barrier
    s_mov_b32 s34, 655360
    s_add_u32 m0, s28, 0
    s_nop 0
    buffer_load_dwordx4 v4, s[52:55], s34 offen lds
    s_add_u32 m0, s29, 0
    s_nop 0
    buffer_load_dwordx4 v5, s[52:55], s34 offen lds
    s_add_u32 m0, s30, 0
    s_nop 0
    buffer_load_dwordx4 v6, s[52:55], s34 offen lds
    ds_read_b64_tr_b16 v[100:101], v8 offset:20480
    ds_read_b64_tr_b16 v[102:103], v8 offset:23040
    ds_read_b64_tr_b16 v[104:105], v8 offset:20512
    ds_read_b64_tr_b16 v[106:107], v8 offset:23072
    ds_read_b64_tr_b16 v[108:109], v8 offset:20544
    ds_read_b64_tr_b16 v[110:111], v8 offset:23104
    ds_read_b64_tr_b16 v[112:113], v8 offset:20576
    ds_read_b64_tr_b16 v[114:115], v8 offset:23136
    ds_read_b64_tr_b16 v[116:117], v8 offset:20608
    ds_read_b64_tr_b16 v[118:119], v8 offset:23168
    s_waitcnt vmcnt(15) lgkmcnt(0)
    v_mfma_f32_16x16x32_bf16 v[20:23], v[100:103], v[68:71], v[20:23]
    v_mfma_f32_16x16x32_bf16 v[24:27], v[100:103], v[72:75], v[24:27]
    v_mfma_f32_16x16x32_bf16 v[28:31], v[104:107], v[68:71], v[28:31]
    v_mfma_f32_16x16x32_bf16 v[32:35], v[104:107], v[72:75], v[32:35]
    v_mfma_f32_16x16x32_bf16 v[36:39], v[108:111], v[68:71], v[36:39]
    v_mfma_f32_16x16x32_bf16 v[40:43], v[108:111], v[72:75], v[40:43]
    v_mfma_f32_16x16x32_bf16 v[44:47], v[112:115], v[68:71], v[44:47]
    v_mfma_f32_16x16x32_bf16 v[48:51], v[112:115], v[72:75], v[48:51]
    v_mfma_f32_16x16x32_bf16 v[52:55], v[116:119], v[68:71], v[52:55]
    v_mfma_f32_16x16x32_bf16 v[56:59], v[116:119], v[72:75], v[56:59]
    ds_read_b64_tr_b16 v[100:101], v8 offset:40960
    ds_read_b64_tr_b16 v[102:103], v8 offset:43520
    ds_read_b64_tr_b16 v[104:105], v8 offset:40992
    ds_read_b64_tr_b16 v[106:107], v8 offset:43552
    ds_read_b64_tr_b16 v[108:109], v8 offset:41024
    ds_read_b64_tr_b16 v[110:111], v8 offset:43584
    ds_read_b64_tr_b16 v[112:113], v8 offset:41056
    ds_read_b64_tr_b16 v[114:115], v8 offset:43616
    ds_read_b64_tr_b16 v[116:117], v8 offset:41088
    ds_read_b64_tr_b16 v[118:119], v8 offset:43648
    s_waitcnt vmcnt(11) lgkmcnt(0)
    v_mfma_f32_16x16x32_bf16 v[20:23], v[100:103], v[76:79], v[20:23]
    v_mfma_f32_16x16x32_bf16 v[24:27], v[100:103], v[80:83], v[24:27]
    v_mfma_f32_16x16x32_bf16 v[28:31], v[104:107], v[76:79], v[28:31]
    v_mfma_f32_16x16x32_bf16 v[32:35], v[104:107], v[80:83], v[32:35]
    v_mfma_f32_16x16x32_bf16 v[36:39], v[108:111], v[76:79], v[36:39]
    v_mfma_f32_16x16x32_bf16 v[40:43], v[108:111], v[80:83], v[40:43]
    v_mfma_f32_16x16x32_bf16 v[44:47], v[112:115], v[76:79], v[44:47]
    v_mfma_f32_16x16x32_bf16 v[48:51], v[112:115], v[80:83], v[48:51]
    v_mfma_f32_16x16x32_bf16 v[52:55], v[116:119], v[76:79], v[52:55]
    v_mfma_f32_16x16x32_bf16 v[56:59], v[116:119], v[80:83], v[56:59]
    s_barrier
    v_add_u32 v19, 61440, v8
    ds_read_b64_tr_b16 v[100:101], v19 offset:0
    ds_read_b64_tr_b16 v[102:103], v19 offset:2560
    ds_read_b64_tr_b16 v[104:105], v19 offset:32
    ds_read_b64_tr_b16 v[106:107], v19 offset:2592
    ds_read_b64_tr_b16 v[108:109], v19 offset:64
    ds_read_b64_tr_b16 v[110:111], v19 offset:2624
    ds_read_b64_tr_b16 v[112:113], v19 offset:96
    ds_read_b64_tr_b16 v[114:115], v19 offset:2656
    ds_read_b64_tr_b16 v[116:117], v19 offset:128
    ds_read_b64_tr_b16 v[118:119], v19 offset:2688
    s_waitcnt vmcnt(7) lgkmcnt(0)
    v_mfma_f32_16x16x32_bf16 v[20:23], v[100:103], v[84:87], v[20:23]
    v_mfma_f32_16x16x32_bf16 v[24:27], v[100:103], v[88:91], v[24:27]
    v_mfma_f32_16x16x32_bf16 v[28:31], v[104:107], v[84:87], v[28:31]
    v_mfma_f32_16x16x32_bf16 v[32:35], v[104:107], v[88:91], v[32:35]
    v_mfma_f32_16x16x32_bf16 v[36:39], v[108:111], v[84:87], v[36:39]
    v_mfma_f32_16x16x32_bf16 v[40:43], v[108:111], v[88:91], v[40:43]
    v_mfma_f32_16x16x32_bf16 v[44:47], v[112:115], v[84:87], v[44:47]
    v_mfma_f32_16x16x32_bf16 v[48:51], v[112:115], v[88:91], v[48:51]
    v_mfma_f32_16x16x32_bf16 v[52:55], v[116:119], v[84:87], v[52:55]
    v_mfma_f32_16x16x32_bf16 v[56:59], v[116:119], v[88:91], v[56:59]
    s_waitcnt vmcnt(0)
    s_barrier
    ds_read_b64_tr_b16 v[100:101], v8 offset:0
    ds_read_b64_tr_b16 v[102:103], v8 offset:2560
    ds_read_b64_tr_b16 v[104:105], v8 offset:32
    ds_read_b64_tr_b16 v[106:107], v8 offset:2592
    ds_read_b64_tr_b16 v[108:109], v8 offset:64
    ds_read_b64_tr_b16 v[110:111], v8 offset:2624
    ds_read_b64_tr_b16 v[112:113], v8 offset:96
    ds_read_b64_tr_b16 v[114:115], v8 offset:2656
    ds_read_b64_tr_b16 v[116:117], v8 offset:128
    ds_read_b64_tr_b16 v[118:119], v8 offset:2688
    v_add_u32 v10, 512, v0
    v_min_u32 v10, 639, v10
    v_mul_u32_u24 v11, 6554, v10
    v_lshrrev_b32 v11, 16, v11
    v_mul_u32_u24 v12, 10, v11
    v_sub_u32 v12, v10, v12
    v_bfe_u32 v16, v11, 1, 2
    v_lshlrev_b32 v17, 1, v12
    v_xor_b32 v17, v17, v16
    v_mul_u32_u24 v18, 320, v11
    v_lshl_add_u32 v13, v17, 4, v18
    v_xor_b32 v17, 1, v17
    v_lshl_add_u32 v15, v17, 4, v18
    s_lshl_b32 s37, s20, 6
    v_add_u32 v14, s37, v11
    v_mul_u32_u24 v14, 1280, v14
    v_lshl_add_u32 v14, v12, 4, v14
    s_mul_i32 s37, s21, 160
    v_add_u32 v14, s37, v14
    buffer_load_dwordx4 v[64:67], v14, s[48:51], 0 offen
    v_add_u32 v10, 0, v0
    v_min_u32 v10, 639, v10
    v_mul_u32_u24 v11, 6554, v10
    v_lshrrev_b32 v11, 16, v11
    v_mul_u32_u24 v12, 10, v11
    v_sub_u32 v12, v10, v12
    v_bfe_u32 v16, v11, 1, 2
    v_lshlrev_b32 v17, 1, v12
    v_xor_b32 v17, v17, v16
    v_mul_u32_u24 v18, 320, v11
    v_lshl_add_u32 v13, v17, 4, v18
    v_xor_b32 v17, 1, v17
    v_lshl_add_u32 v15, v17, 4, v18
    s_lshl_b32 s37, s20, 6
    v_add_u32 v14, s37, v11
    v_mul_u32_u24 v14, 1280, v14
    v_lshl_add_u32 v14, v12, 4, v14
    s_mul_i32 s37, s21, 160
    v_add_u32 v14, s37, v14
    buffer_load_dwordx4 v[60:63], v14, s[48:51], 0 offen
    s_waitcnt lgkmcnt(0)
    v_mfma_f32_16x16x32_bf16 v[20:23], v[100:103], v[92:95], v[20:23]
    v_mfma_f32_16x16x32_bf16 v[24:27], v[100:103], v[96:99], v[24:27]
    v_mfma_f32_16x16x32_bf16 v[28:31], v[104:107], v[92:95], v[28:31]
    v_mfma_f32_16x16x32_bf16 v[32:35], v[104:107], v[96:99], v[32:35]
    v_mfma_f32_16x16x32_bf16 v[36:39], v[108:111], v[92:95], v[36:39]
    v_mfma_f32_16x16x32_bf16 v[40:43], v[108:111], v[96:99], v[40:43]
    v_mfma_f32_16x16x32_bf16 v[44:47], v[112:115], v[92:95], v[44:47]
    v_mfma_f32_16x16x32_bf16 v[48:51], v[112:115], v[96:99], v[48:51]
    v_mfma_f32_16x16x32_bf16 v[52:55], v[116:119], v[92:95], v[52:55]
    v_mfma_f32_16x16x32_bf16 v[56:59], v[116:119], v[96:99], v[56:59]
    s_barrier
    s_nop 4
    ds_write_b128 v9, v[20:23] offset:0
    ds_write_b128 v9, v[24:27] offset:5120
    ds_write_b128 v9, v[28:31] offset:64
    ds_write_b128 v9, v[32:35] offset:5184
    ds_write_b128 v9, v[36:39] offset:128
    ds_write_b128 v9, v[40:43] offset:5248
    ds_write_b128 v9, v[44:47] offset:192
    ds_write_b128 v9, v[48:51] offset:5312
    ds_write_b128 v9, v[52:55] offset:256
    ds_write_b128 v9, v[56:59] offset:5376
    s_waitcnt lgkmcnt(0)
    s_barrier
    ds_read_b128 v[20:23], v13 offset:0
    ds_read_b128 v[24:27], v15 offset:0
    ds_read_b128 v[28:31], v13 offset:20480
    ds_read_b128 v[32:35], v15 offset:20480
    ds_read_b128 v[36:39], v13 offset:40960
    ds_read_b128 v[40:43], v15 offset:40960
    ds_read_b128 v[44:47], v13 offset:61440
    ds_read_b128 v[48:51], v15 offset:61440
    s_waitcnt lgkmcnt(0)
    v_add_f32 v20, v20, v28
    v_add_f32 v21, v21, v29
    v_add_f32 v22, v22, v30
    v_add_f32 v23, v23, v31
    v_add_f32 v24, v24, v32
    v_add_f32 v25, v25, v33
    v_add_f32 v26, v26, v34
    v_add_f32 v27, v27, v35
    v_add_f32 v36, v36, v44
    v_add_f32 v37, v37, v45
    v_add_f32 v38, v38, v46
    v_add_f32 v39, v39, v47
    v_add_f32 v40, v40, v48
    v_add_f32 v41, v41, v49
    v_add_f32 v42, v42, v50
    v_add_f32 v43, v43, v51
    v_add_f32 v20, v20, v36
    v_add_f32 v21, v21, v37
    v_add_f32 v22, v22, v38
    v_add_f32 v23, v23, v39
    v_add_f32 v24, v24, v40
    v_add_f32 v25, v25, v41
    v_add_f32 v26, v26, v42
    v_add_f32 v27, v27, v43
    v_cvt_pk_bf16_f32 v20, v20, v21
    v_and_b32 v21, 0xffff0000, v20
    v_lshlrev_b32 v20, 16, v20
    v_cvt_pk_bf16_f32 v22, v22, v23
    v_and_b32 v23, 0xffff0000, v22
    v_lshlrev_b32 v22, 16, v22
    v_cvt_pk_bf16_f32 v24, v24, v25
    v_and_b32 v25, 0xffff0000, v24
    v_lshlrev_b32 v24, 16, v24
    v_cvt_pk_bf16_f32 v26, v26, v27
    v_and_b32 v27, 0xffff0000, v26
    v_lshlrev_b32 v26, 16, v26
    s_waitcnt vmcnt(0)
    v_lshlrev_b32 v68, 16, v120
    v_and_b32 v69, 0xffff0000, v120
    v_lshlrev_b32 v70, 16, v121
    v_and_b32 v71, 0xffff0000, v121
    v_lshlrev_b32 v72, 16, v122
    v_and_b32 v73, 0xffff0000, v122
    v_lshlrev_b32 v74, 16, v123
    v_and_b32 v75, 0xffff0000, v123
    v_mul_f32 v20, v20, v68
    v_mul_f32 v21, v21, v69
    v_mul_f32 v22, v22, v70
    v_mul_f32 v23, v23, v71
    v_mul_f32 v24, v24, v72
    v_mul_f32 v25, v25, v73
    v_mul_f32 v26, v26, v74
    v_mul_f32 v27, v27, v75
    v_cvt_pk_bf16_f32 v20, v20, v21
    v_and_b32 v21, 0xffff0000, v20
    v_lshlrev_b32 v20, 16, v20
    v_cvt_pk_bf16_f32 v22, v22, v23
    v_and_b32 v23, 0xffff0000, v22
    v_lshlrev_b32 v22, 16, v22
    v_cvt_pk_bf16_f32 v24, v24, v25
    v_and_b32 v25, 0xffff0000, v24
    v_lshlrev_b32 v24, 16, v24
    v_cvt_pk_bf16_f32 v26, v26, v27
    v_and_b32 v27, 0xffff0000, v26
    v_lshlrev_b32 v26, 16, v26
    v_lshlrev_b32 v68, 16, v60
    v_and_b32 v69, 0xffff0000, v60
    v_lshlrev_b32 v70, 16, v61
    v_and_b32 v71, 0xffff0000, v61
    v_lshlrev_b32 v72, 16, v62
    v_and_b32 v73, 0xffff0000, v62
    v_lshlrev_b32 v74, 16, v63
    v_and_b32 v75, 0xffff0000, v63
    v_add_f32 v20, v20, v68
    v_add_f32 v21, v21, v69
    v_add_f32 v22, v22, v70
    v_add_f32 v23, v23, v71
    v_add_f32 v24, v24, v72
    v_add_f32 v25, v25, v73
    v_add_f32 v26, v26, v74
    v_add_f32 v27, v27, v75
    v_cvt_pk_bf16_f32 v100, v20, v21
    v_cvt_pk_bf16_f32 v101, v22, v23
    v_cvt_pk_bf16_f32 v102, v24, v25
    v_cvt_pk_bf16_f32 v103, v26, v27
    buffer_store_dwordx4 v[100:103], v14, s[16:19], 0 offen
    s_cmp_ge_u32 s23, 2
    s_cbranch_scc1 L_mb_done
    v_add_u32 v10, 512, v0
    v_min_u32 v10, 639, v10
    v_mul_u32_u24 v11, 6554, v10
    v_lshrrev_b32 v11, 16, v11
    v_mul_u32_u24 v12, 10, v11
    v_sub_u32 v12, v10, v12
    v_bfe_u32 v16, v11, 1, 2
    v_lshlrev_b32 v17, 1, v12
    v_xor_b32 v17, v17, v16
    v_mul_u32_u24 v18, 320, v11
    v_lshl_add_u32 v13, v17, 4, v18
    v_xor_b32 v17, 1, v17
    v_lshl_add_u32 v15, v17, 4, v18
    s_lshl_b32 s37, s20, 6
    v_add_u32 v14, s37, v11
    v_mul_u32_u24 v14, 1280, v14
    v_lshl_add_u32 v14, v12, 4, v14
    s_mul_i32 s37, s21, 160
    v_add_u32 v14, s37, v14
    ds_read_b128 v[20:23], v13 offset:0
    ds_read_b128 v[24:27], v15 offset:0
    ds_read_b128 v[28:31], v13 offset:20480
    ds_read_b128 v[32:35], v15 offset:20480
    ds_read_b128 v[36:39], v13 offset:40960
    ds_read_b128 v[40:43], v15 offset:40960
    ds_read_b128 v[44:47], v13 offset:61440
    ds_read_b128 v[48:51], v15 offset:61440
    s_waitcnt lgkmcnt(0)
    v_add_f32 v20, v20, v28
    v_add_f32 v21, v21, v29
    v_add_f32 v22, v22, v30
    v_add_f32 v23, v23, v31
    v_add_f32 v24, v24, v32
    v_add_f32 v25, v25, v33
    v_add_f32 v26, v26, v34
    v_add_f32 v27, v27, v35
    v_add_f32 v36, v36, v44
    v_add_f32 v37, v37, v45
    v_add_f32 v38, v38, v46
    v_add_f32 v39, v39, v47
    v_add_f32 v40, v40, v48
    v_add_f32 v41, v41, v49
    v_add_f32 v42, v42, v50
    v_add_f32 v43, v43, v51
    v_add_f32 v20, v20, v36
    v_add_f32 v21, v21, v37
    v_add_f32 v22, v22, v38
    v_add_f32 v23, v23, v39
    v_add_f32 v24, v24, v40
    v_add_f32 v25, v25, v41
    v_add_f32 v26, v26, v42
    v_add_f32 v27, v27, v43
    v_cvt_pk_bf16_f32 v20, v20, v21
    v_and_b32 v21, 0xffff0000, v20
    v_lshlrev_b32 v20, 16, v20
    v_cvt_pk_bf16_f32 v22, v22, v23
    v_and_b32 v23, 0xffff0000, v22
    v_lshlrev_b32 v22, 16, v22
    v_cvt_pk_bf16_f32 v24, v24, v25
    v_and_b32 v25, 0xffff0000, v24
    v_lshlrev_b32 v24, 16, v24
    v_cvt_pk_bf16_f32 v26, v26, v27
    v_and_b32 v27, 0xffff0000, v26
    v_lshlrev_b32 v26, 16, v26
    v_lshlrev_b32 v68, 16, v124
    v_and_b32 v69, 0xffff0000, v124
    v_lshlrev_b32 v70, 16, v125
    v_and_b32 v71, 0xffff0000, v125
    v_lshlrev_b32 v72, 16, v126
    v_and_b32 v73, 0xffff0000, v126
    v_lshlrev_b32 v74, 16, v127
    v_and_b32 v75, 0xffff0000, v127
    v_mul_f32 v20, v20, v68
    v_mul_f32 v21, v21, v69
    v_mul_f32 v22, v22, v70
    v_mul_f32 v23, v23, v71
    v_mul_f32 v24, v24, v72
    v_mul_f32 v25, v25, v73
    v_mul_f32 v26, v26, v74
    v_mul_f32 v27, v27, v75
    v_cvt_pk_bf16_f32 v20, v20, v21
    v_and_b32 v21, 0xffff0000, v20
    v_lshlrev_b32 v20, 16, v20
    v_cvt_pk_bf16_f32 v22, v22, v23
    v_and_b32 v23, 0xffff0000, v22
    v_lshlrev_b32 v22, 16, v22
    v_cvt_pk_bf16_f32 v24, v24, v25
    v_and_b32 v25, 0xffff0000, v24
    v_lshlrev_b32 v24, 16, v24
    v_cvt_pk_bf16_f32 v26, v26, v27
    v_and_b32 v27, 0xffff0000, v26
    v_lshlrev_b32 v26, 16, v26
    v_lshlrev_b32 v68, 16, v64
    v_and_b32 v69, 0xffff0000, v64
    v_lshlrev_b32 v70, 16, v65
    v_and_b32 v71, 0xffff0000, v65
    v_lshlrev_b32 v72, 16, v66
    v_and_b32 v73, 0xffff0000, v66
    v_lshlrev_b32 v74, 16, v67
    v_and_b32 v75, 0xffff0000, v67
    v_add_f32 v20, v20, v68
    v_add_f32 v21, v21, v69
    v_add_f32 v22, v22, v70
    v_add_f32 v23, v23, v71
    v_add_f32 v24, v24, v72
    v_add_f32 v25, v25, v73
    v_add_f32 v26, v26, v74
    v_add_f32 v27, v27, v75
    v_cvt_pk_bf16_f32 v104, v20, v21
    v_cvt_pk_bf16_f32 v105, v22, v23
    v_cvt_pk_bf16_f32 v106, v24, v25
    v_cvt_pk_bf16_f32 v107, v26, v27
    buffer_store_dwordx4 v[104:107], v14, s[16:19], 0 offen
L_mb_done:
L_kf_fin:
    s_mov_b32 s2, s96
L_kf_end:
    s_endpgm
L_kf_codeend:
.section .rodata,"a"
.p2align 6
.amdhsa_kernel recurrent_scan__softmax_full_mha__mixer_channel_mlp__prompt_kernel
  .amdhsa_next_free_vgpr 128
  .amdhsa_next_free_sgpr 102
  .amdhsa_accum_offset 128
  .amdhsa_group_segment_fixed_size 0
  .amdhsa_kernarg_size 88
  .amdhsa_user_sgpr_count 2
  .amdhsa_user_sgpr_kernarg_segment_ptr 1
  .amdhsa_system_sgpr_workgroup_id_x 1
.end_amdhsa_kernel
```
